```python
import torch

def _softmax(x, axis=-1):
    return torch.softmax(x, dim=axis)
def _gelu(x):
    return torch.nn.functional.gelu(x, approximate="tanh")
def _silu(x):
    return torch.nn.functional.silu(x)
def _sigmoid(x):
    return torch.sigmoid(x)
def _layernorm(x, axis=-1, eps=1e-5):
    m = x.mean(dim=axis, keepdim=True)
    v = x.var(dim=axis, keepdim=True, unbiased=False)
    return (x - m) / torch.sqrt(v + eps)
def _scatter_add(tgt, idx, src, axis=0):
    return tgt.clone().index_add_(axis, idx, src)
def _segment_sum(src, seg, n):
    out = torch.zeros((n,) + src.shape[1:], dtype=src.dtype)
    return out.index_add_(0, seg, src)
def _pad(x, pw):
    flat = tuple(v for pair in reversed(pw) for v in pair)
    return torch.nn.functional.pad(x, flat)

kernel_name = 'gated_mix__grouped_kv_mqa__spectral_gfnet__prompt'

def setup_inputs():

    _w = (lambda a: (lambda t: t.to(torch.bfloat16) if t.is_floating_point() else t)(torch.as_tensor(a)))
    def _A_setup():
        B, S, D, H = 1, 2048, 640, 32
        Dh = D // H
        return {
            "x": _w((lambda *s: torch.randn(*s, dtype=torch.bfloat16) * 0.05)(B, S, D)),
            "wq": _w((lambda *s: torch.randn(*s, dtype=torch.bfloat16) * 0.8)(D, H * Dh)),
            "wk": _w((lambda *s: torch.randn(*s, dtype=torch.bfloat16) * 0.8)(D, Dh)),
            "wv": _w((lambda *s: torch.randn(*s, dtype=torch.bfloat16) * 0.05)(D, Dh)),
            "wo": _w((lambda *s: torch.randn(*s, dtype=torch.bfloat16) * 0.05)(H * Dh, D)),
        }
    _A_in = _A_setup()

    def _B_setup():
        B, S, D = 1, 2048, 640
        Df = D // 2 + 1
        return {
            "x": _w((lambda *s: torch.randn(*s, dtype=torch.bfloat16) * 0.05)(B, S, D)),
            "w_r": _w((lambda *s: torch.randn(*s, dtype=torch.bfloat16) * 0.8)(S, Df) * 0.02),
            "w_i": _w((lambda *s: torch.randn(*s, dtype=torch.bfloat16) * 0.8)(S, Df) * 0.02),
        }
    _B_in = _B_setup()

    return {
        "A_x": _A_in["x"],
        "A_wq": _A_in["wq"],
        "A_wk": _A_in["wk"],
        "A_wv": _A_in["wv"],
        "A_wo": _A_in["wo"],
        "B_x": _B_in["x"],
        "B_w_r": _B_in["w_r"],
        "B_w_i": _B_in["w_i"],
        "gate_w": _w((lambda *s: torch.randn(*s, dtype=torch.bfloat16) * 0.05)(640) * 16.0),
    }

def reference(A_x, A_wq, A_wk, A_wv, A_wo, B_x, B_w_r, B_w_i, gate_w):
    def _A_ref(x, wq, wk, wv, wo):
        B, S, D = x.shape
        H = 32
        Dh = D // H
        q = (lambda x, *d: x.permute(*d))((x @ wq).reshape(B, S, H, Dh), 0, 2, 1, 3)
        k = x @ wk
        v = x @ wv
        scores = torch.einsum("bhqd,bkd->bhqk", q, k) * (Dh ** -0.5)
        p = _softmax(scores, axis=-1)
        o = torch.einsum("bhqk,bkd->bhqd", p, v)
        return (lambda x, *d: x.permute(*d))(o, 0, 2, 1, 3).reshape(B, S, H * Dh) @ wo

    def _B_ref(x, w_r, w_i):
        B, S, D = x.shape
        X = (lambda x, axes=(-2,-1): torch.fft.rfft2(x.float(), dim=axes))(x, axes=(-2, -1))
        W = w_r + 1j * w_i
        X = X * W
        y = (lambda x, s, axes=(-2,-1): torch.fft.irfft2(x, s=s, dim=axes).to(torch.bfloat16))(X, (S, D), axes=(-2, -1))
        return y

    x = A_x
    g = _sigmoid((x * gate_w).sum(-1, keepdims=True))
    a = _A_ref(x, A_wq, A_wk, A_wv, A_wo)
    b = _B_ref(x, B_w_r, B_w_i)
    return g * a + (1 - g) * b
```

```asm
; @launch grid=(256,1,1) block=(512,1,1) lds=163840
.amdgcn_target "amdgcn-amd-amdhsa--gfx950"
.text
.globl gated_mix__grouped_kv_mqa__spectral_gfnet__prompt_kernel
.p2align 8
.type gated_mix__grouped_kv_mqa__spectral_gfnet__prompt_kernel,@function
gated_mix__grouped_kv_mqa__spectral_gfnet__prompt_kernel:
  s_cmp_ge_u32 s2, 256
  s_cbranch_scc1 L_end
  s_load_dwordx16 s[64:79], s[0:1], 0
  s_load_dwordx8 s[80:87], s[0:1], 64
  v_and_b32 v1, 63, v0
  v_lshrrev_b32 v15, 6, v0
  v_and_b32 v2, 15, v0
  v_readfirstlane_b32 s3, v15
  v_lshrrev_b32 v3, 4, v1
  v_and_b32 v4, 31, v0
  v_lshrrev_b32 v5, 5, v1
  v_lshlrev_b32 v14, 4, v1
  v_mov_b32 v112, 0
  v_mov_b32 v113, 0
  v_mov_b32 v114, 0
  v_mov_b32 v8, 0
  v_mov_b32 v12, 0
  v_mov_b32 v37, 0
  v_mov_b32 v39, 0
  v_mov_b32 v100, 0
  v_mov_b32 v101, 0
  v_mov_b32 v102, 0
  v_mov_b32 v103, 0
  v_mov_b32 v104, 0
  s_and_b32 s48, s2, 7
  s_lshr_b32 s56, s2, 3
  s_and_b32 s49, s56, 7
  s_lshr_b32 s56, s56, 3
  s_lshl_b32 s56, s56, 3
  s_add_u32 s48, s48, s56
  s_and_b32 s51, s3, 3
  s_lshr_b32 s52, s3, 2
  s_lshl_b32 s53, s3, 10
  s_waitcnt lgkmcnt(0)
  s_mov_b32 s12, s64
  s_and_b32 s13, s65, 0xffff
  s_mov_b32 s14, 0x280000
  s_mov_b32 s15, 0x20000
  s_mov_b32 s16, s66
  s_and_b32 s17, s67, 0xffff
  s_mov_b32 s18, 0xc8000
  s_mov_b32 s19, 0x20000
  s_cmp_ge_u32 s49, 4
  s_cselect_b32 s90, s70, s68
  s_cselect_b32 s91, s71, s69
  s_mov_b32 s20, s90
  s_and_b32 s21, s91, 0xffff
  s_mov_b32 s22, 0x6400
  s_mov_b32 s23, 0x20000
  s_mul_i32 s58, s48, 81920
  s_mov_b64 exec, 1
  buffer_load_dword v110, off, s[12:15], s58
  buffer_load_dword v110, off, s[16:19], 0
  buffer_load_dword v110, off, s[20:23], 0
  s_mov_b64 exec, -1
  s_mov_b32 s8, s86
  s_and_b32 s9, s87, 0xffff
  s_mov_b32 s10, 0x1280000
  s_mov_b32 s11, 0x20000
  s_add_u32 s88, s86, 17956864
  s_addc_u32 s89, s87, 0
  s_load_dword s50, s[88:89], 0
  s_mov_b32 s24, s64
  s_and_b32 s25, s65, 0xffff
  s_mov_b32 s26, 0x280000
  s_mov_b32 s27, 0x20000
  s_mov_b32 s28, s72
  s_and_b32 s29, s73, 0xffff
  s_mov_b32 s30, 0xc8000
  s_mov_b32 s31, 0x20000
  s_mov_b32 s32, s82
  s_and_b32 s33, s83, 0xffff
  s_mov_b32 s34, 0x280000
  s_mov_b32 s35, 0x20000
  s_mov_b32 s36, s76
  s_and_b32 s37, s77, 0xffff
  s_mov_b32 s38, 0x141000
  s_mov_b32 s39, 0x20000
  s_mov_b32 s40, s78
  s_and_b32 s41, s79, 0xffff
  s_mov_b32 s42, 0x141000
  s_mov_b32 s43, 0x20000
  s_mov_b32 s44, s80
  s_and_b32 s45, s81, 0xffff
  s_mov_b32 s46, 0x500
  s_mov_b32 s47, 0x20000
  s_lshr_b32 s56, s48, 3
  s_lshl_b32 s56, s56, 1
  s_add_u32 s56, s56, s49
  s_cmp_ge_u32 s56, 5
  s_cselect_b32 s57, 5, 0
  s_sub_u32 s56, s56, s57
  s_cmp_ge_u32 s56, 5
  s_cselect_b32 s57, 5, 0
  s_sub_u32 s56, s56, s57
  s_add_u32 s4, s56, 0
  s_cmp_ge_u32 s4, 5
  s_cselect_b32 s57, 5, 0
  s_sub_u32 s4, s4, s57
  s_add_u32 s5, s56, 1
  s_cmp_ge_u32 s5, 5
  s_cselect_b32 s57, 5, 0
  s_sub_u32 s5, s5, s57
  s_add_u32 s6, s56, 2
  s_cmp_ge_u32 s6, 5
  s_cselect_b32 s57, 5, 0
  s_sub_u32 s6, s6, s57
  s_add_u32 s7, s56, 3
  s_cmp_ge_u32 s7, 5
  s_cselect_b32 s57, 5, 0
  s_sub_u32 s7, s7, s57
  s_add_u32 s54, s56, 4
  s_cmp_ge_u32 s54, 5
  s_cselect_b32 s57, 5, 0
  s_sub_u32 s54, s54, s57
  v_lshlrev_b32 v15, 2, v1
  v_add_u32 v15, 162816, v15
  v_mov_b32 v80, 0
  ds_write_b32 v15, v80
  s_mul_i32 s81, s49, 160
  s_mul_i32 s80, s48, 81920
  s_lshl_b32 s56, s3, 2
  v_add_u32 v80, s56, v3
  v_and_b32 v81, 15, v80
  v_xor_b32 v81, v81, v2
  v_lshlrev_b32 v81, 4, v81
  v_mul_u32_u24 v37, 1280, v80
  v_add_u32 v37, v37, v81
  s_mul_i32 s76, s4, 256
  s_add_u32 s76, s76, s80
  s_add_u32 m0, s53, 0
  s_nop 0
  buffer_load_dwordx4 v37, s[12:15], s76 offen lds
  s_mul_i32 s76, s4, 256
  s_add_u32 s76, s76, s80
  s_add_u32 s76, s76, 40960
  s_add_u32 m0, s53, 8192
  s_nop 0
  buffer_load_dwordx4 v37, s[12:15], s76 offen lds
  s_mul_i32 s76, s5, 256
  s_add_u32 s76, s76, s80
  s_add_u32 m0, s53, 16384
  s_nop 0
  buffer_load_dwordx4 v37, s[12:15], s76 offen lds
  s_mul_i32 s76, s5, 256
  s_add_u32 s76, s76, s80
  s_add_u32 s76, s76, 40960
  s_add_u32 m0, s53, 24576
  s_nop 0
  buffer_load_dwordx4 v37, s[12:15], s76 offen lds
  s_mul_i32 s76, s6, 256
  s_add_u32 s76, s76, s80
  s_add_u32 m0, s53, 32768
  s_nop 0
  buffer_load_dwordx4 v37, s[12:15], s76 offen lds
  s_mul_i32 s76, s6, 256
  s_add_u32 s76, s76, s80
  s_add_u32 s76, s76, 40960
  s_add_u32 m0, s53, 40960
  s_nop 0
  buffer_load_dwordx4 v37, s[12:15], s76 offen lds
  s_mul_i32 s76, s7, 256
  s_add_u32 s76, s76, s80
  s_add_u32 m0, s53, 49152
  s_nop 0
  buffer_load_dwordx4 v37, s[12:15], s76 offen lds
  s_mul_i32 s76, s7, 256
  s_add_u32 s76, s76, s80
  s_add_u32 s76, s76, 40960
  s_add_u32 m0, s53, 57344
  s_nop 0
  buffer_load_dwordx4 v37, s[12:15], s76 offen lds
  s_mul_i32 s76, s54, 256
  s_add_u32 s76, s76, s80
  s_add_u32 m0, s53, 65536
  s_nop 0
  buffer_load_dwordx4 v37, s[12:15], s76 offen lds
  s_mul_i32 s76, s54, 256
  s_add_u32 s76, s76, s80
  s_add_u32 s76, s76, 40960
  s_add_u32 m0, s53, 73728
  s_nop 0
  buffer_load_dwordx4 v37, s[12:15], s76 offen lds
  s_cmp_ge_u32 s3, 3
  s_cbranch_scc1 wkv_2
  s_cmp_ge_u32 s3, 1
  s_cbranch_scc1 wkv_1
  s_mov_b32 s76, 24576
  s_mov_b32 m0, 147456
  s_nop 0
  buffer_load_dwordx4 v14, s[20:23], s76 offen lds
  s_branch wkv_2
wkv_1:
  s_sub_u32 s76, s53, 1024
  s_add_u32 m0, s76, 148480
  s_nop 0
  buffer_load_dwordx4 v14, s[44:47], s76 offen lds
wkv_2:
  s_add_u32 s76, s53, 0
  s_add_u32 m0, s53, 122880
  s_nop 0
  buffer_load_dwordx4 v14, s[20:23], s76 offen lds
  s_add_u32 s76, s53, 8192
  s_add_u32 m0, s53, 131072
  s_nop 0
  buffer_load_dwordx4 v14, s[20:23], s76 offen lds
  s_add_u32 s76, s53, 16384
  s_add_u32 m0, s53, 139264
  s_nop 0
  buffer_load_dwordx4 v14, s[20:23], s76 offen lds
  s_lshl_b32 s59, s52, 2
  s_add_u32 s59, s59, s3
  s_add_u32 s58, s59, 0
  s_lshl_b32 s56, s58, 6
  v_add_u32 v80, s56, v1
  v_mul_u32_u24 v81, 6554, v80
  v_lshrrev_b32 v81, 16, v81
  v_mul_u32_u24 v82, 10, v81
  v_sub_u32 v80, v80, v82
  v_and_b32 v82, 15, v81
  v_and_b32 v83, 3, v82
  v_and_b32 v84, 4, v82
  v_lshl_add_u32 v83, v84, 1, v83
  v_and_b32 v84, 8, v82
  v_lshrrev_b32 v84, 1, v84
  v_add_u32 v83, v83, v84
  v_and_b32 v81, 0x70, v81
  v_add_u32 v81, v81, v83
  v_mul_u32_u24 v113, 1280, v81
  v_lshl_add_u32 v113, v80, 4, v113
  s_add_u32 s58, s59, 4
  s_lshl_b32 s56, s58, 6
  v_add_u32 v80, s56, v1
  v_mul_u32_u24 v81, 6554, v80
  v_lshrrev_b32 v81, 16, v81
  v_mul_u32_u24 v82, 10, v81
  v_sub_u32 v80, v80, v82
  v_and_b32 v82, 15, v81
  v_and_b32 v83, 3, v82
  v_and_b32 v84, 4, v82
  v_lshl_add_u32 v83, v84, 1, v83
  v_and_b32 v84, 8, v82
  v_lshrrev_b32 v84, 1, v84
  v_add_u32 v83, v83, v84
  v_and_b32 v81, 0x70, v81
  v_add_u32 v81, v81, v83
  v_mul_u32_u24 v114, 1280, v81
  v_lshl_add_u32 v114, v80, 4, v114
  s_add_u32 s58, s59, 8
  s_lshl_b32 s56, s58, 6
  v_add_u32 v80, s56, v1
  v_mul_u32_u24 v81, 6554, v80
  v_lshrrev_b32 v81, 16, v81
  v_mul_u32_u24 v82, 10, v81
  v_sub_u32 v80, v80, v82
  v_and_b32 v82, 15, v81
  v_and_b32 v83, 3, v82
  v_and_b32 v84, 4, v82
  v_lshl_add_u32 v83, v84, 1, v83
  v_and_b32 v84, 8, v82
  v_lshrrev_b32 v84, 1, v84
  v_add_u32 v83, v83, v84
  v_and_b32 v81, 0x70, v81
  v_add_u32 v81, v81, v83
  v_mul_u32_u24 v39, 1280, v81
  v_lshl_add_u32 v39, v80, 4, v39
  v_and_b32 v80, 3, v2
  v_xor_b32 v80, v80, v3
  v_lshlrev_b32 v80, 4, v80
  v_lshl_add_u32 v80, v2, 8, v80
  s_lshl_b32 s56, s51, 12
  s_add_u32 s56, s56, 0
  v_add_u32 v80, s56, v80
  v_lshrrev_b32 v81, 2, v2
  v_xor_b32 v8, 0, v81
  v_lshl_add_u32 v8, v8, 6, v80
  v_xor_b32 v9, 1, v81
  v_lshl_add_u32 v9, v9, 6, v80
  v_xor_b32 v10, 2, v81
  v_lshl_add_u32 v10, v10, 6, v80
  v_xor_b32 v11, 3, v81
  v_lshl_add_u32 v11, v11, 6, v80
  v_lshrrev_b32 v80, 1, v3
  v_lshlrev_b32 v80, 4, v80
  v_and_b32 v81, 1, v3
  v_lshl_add_u32 v80, v81, 2, v80
  v_lshrrev_b32 v81, 2, v2
  v_add_u32 v80, v80, v81
  v_mul_u32_u24 v12, 160, v80
  v_and_b32 v81, 3, v2
  v_lshl_add_u32 v12, v81, 3, v12
  v_add_u32 v12, 81920, v12
  v_lshlrev_b32 v115, 4, v3
  v_add_u32 v115, 148480, v115
  s_lshl_b32 s70, s2, 3
  s_add_u32 s70, s70, s3
  s_mov_b32 s56, s70
  s_mov_b32 s68, 0
  s_cmp_ge_u32 s56, 1650
  s_cbranch_scc1 tg_7
  s_cmp_ge_u32 s56, 1632
  s_cbranch_scc1 tg_5
  s_cmp_ge_u32 s56, 1600
  s_cbranch_scc1 tg_4
  s_cmp_ge_u32 s56, 800
  s_cselect_b32 s57, 800, 0
  s_sub_u32 s58, s56, s57
  s_mul_i32 s59, s58, 656
  s_lshr_b32 s59, s59, 16
  s_mul_i32 s60, s59, 100
  s_sub_u32 s60, s58, s60
  s_mul_i32 s61, s60, 205
  s_lshr_b32 s61, s61, 10
  s_mul_i32 s62, s61, 5
  s_sub_u32 s62, s60, s62
  s_mul_i32 s63, s59, 80
  s_lshl_b32 s64, s62, 4
  s_add_u32 s63, s63, s64
  v_add_u32 v91, s63, v2
  s_lshl_b32 s64, s61, 5
  v_lshlrev_b32 v95, 3, v3
  v_add_u32 v95, s64, v95
  s_lshl_b32 s65, s58, 10
  s_cmp_ge_u32 s56, 800
  s_cbranch_scc1 tg_3
  s_add_u32 s65, s65, 15728640
  v_lshrrev_b32 v92, 1, v91
  v_mov_b32 v96, 320
  v_cmp_eq_u32 vcc, 1, v91
  v_and_b32 v97, 1, v91
  v_cvt_f32_u32 v93, v97
  v_cndmask_b32 v92, v92, v96, vcc
  v_mul_f32 v93, 0.25, v93
  v_mov_b32 v96, 0
  v_cndmask_b32 v93, v93, v96, vcc
  v_add_u32 v80, 0, v95
  v_mul_u32_u24 v80, v80, v92
  v_lshrrev_b32 v90, 7, v80
  v_mul_u32_u24 v90, 52429, v90
  v_lshrrev_b32 v90, 18, v90
  v_mul_u32_u24 v90, 640, v90
  v_sub_u32 v80, v80, v90
  v_cvt_f32_u32 v80, v80
  v_mov_b32 v90, 0x3acccccd
  v_fma_f32 v80, v80, v90, v93
  v_cos_f32 v80, v80
  v_add_u32 v81, 1, v95
  v_mul_u32_u24 v81, v81, v92
  v_lshrrev_b32 v90, 7, v81
  v_mul_u32_u24 v90, 52429, v90
  v_lshrrev_b32 v90, 18, v90
  v_mul_u32_u24 v90, 640, v90
  v_sub_u32 v81, v81, v90
  v_cvt_f32_u32 v81, v81
  v_mov_b32 v90, 0x3acccccd
  v_fma_f32 v81, v81, v90, v93
  v_cos_f32 v81, v81
  v_add_u32 v82, 2, v95
  v_mul_u32_u24 v82, v82, v92
  v_lshrrev_b32 v90, 7, v82
  v_mul_u32_u24 v90, 52429, v90
  v_lshrrev_b32 v90, 18, v90
  v_mul_u32_u24 v90, 640, v90
  v_sub_u32 v82, v82, v90
  v_cvt_f32_u32 v82, v82
  v_mov_b32 v90, 0x3acccccd
  v_fma_f32 v82, v82, v90, v93
  v_cos_f32 v82, v82
  v_add_u32 v83, 3, v95
  v_mul_u32_u24 v83, v83, v92
  v_lshrrev_b32 v90, 7, v83
  v_mul_u32_u24 v90, 52429, v90
  v_lshrrev_b32 v90, 18, v90
  v_mul_u32_u24 v90, 640, v90
  v_sub_u32 v83, v83, v90
  v_cvt_f32_u32 v83, v83
  v_mov_b32 v90, 0x3acccccd
  v_fma_f32 v83, v83, v90, v93
  v_cos_f32 v83, v83
  v_add_u32 v84, 4, v95
  v_mul_u32_u24 v84, v84, v92
  v_lshrrev_b32 v90, 7, v84
  v_mul_u32_u24 v90, 52429, v90
  v_lshrrev_b32 v90, 18, v90
  v_mul_u32_u24 v90, 640, v90
  v_sub_u32 v84, v84, v90
  v_cvt_f32_u32 v84, v84
  v_mov_b32 v90, 0x3acccccd
  v_fma_f32 v84, v84, v90, v93
  v_cos_f32 v84, v84
  v_add_u32 v85, 5, v95
  v_mul_u32_u24 v85, v85, v92
  v_lshrrev_b32 v90, 7, v85
  v_mul_u32_u24 v90, 52429, v90
  v_lshrrev_b32 v90, 18, v90
  v_mul_u32_u24 v90, 640, v90
  v_sub_u32 v85, v85, v90
  v_cvt_f32_u32 v85, v85
  v_mov_b32 v90, 0x3acccccd
  v_fma_f32 v85, v85, v90, v93
  v_cos_f32 v85, v85
  v_add_u32 v86, 6, v95
  v_mul_u32_u24 v86, v86, v92
  v_lshrrev_b32 v90, 7, v86
  v_mul_u32_u24 v90, 52429, v90
  v_lshrrev_b32 v90, 18, v90
  v_mul_u32_u24 v90, 640, v90
  v_sub_u32 v86, v86, v90
  v_cvt_f32_u32 v86, v86
  v_mov_b32 v90, 0x3acccccd
  v_fma_f32 v86, v86, v90, v93
  v_cos_f32 v86, v86
  v_add_u32 v87, 7, v95
  v_mul_u32_u24 v87, v87, v92
  v_lshrrev_b32 v90, 7, v87
  v_mul_u32_u24 v90, 52429, v90
  v_lshrrev_b32 v90, 18, v90
  v_mul_u32_u24 v90, 640, v90
  v_sub_u32 v87, v87, v90
  v_cvt_f32_u32 v87, v87
  v_mov_b32 v90, 0x3acccccd
  v_fma_f32 v87, v87, v90, v93
  v_cos_f32 v87, v87
  s_nop 0
  v_cvt_pk_bf16_f32 v80, v80, v81
  v_cvt_pk_bf16_f32 v81, v82, v83
  v_cvt_pk_bf16_f32 v82, v84, v85
  v_cvt_pk_bf16_f32 v83, v86, v87
  s_branch tg_6
tg_3:
  s_add_u32 s65, s65, 16777216
  v_add_u32 v96, 0, v95
  v_lshrrev_b32 v92, 1, v96
  v_mov_b32 v93, 0
  v_mov_b32 v94, 0x35cccccd
  v_cmp_ge_u32 vcc, 1, v96
  v_mov_b32 v97, 0x354ccccd
  s_nop 1
  v_cndmask_b32 v94, v94, v97, vcc
  v_mul_u32_u24 v80, v91, v92
  v_lshrrev_b32 v90, 7, v80
  v_mul_u32_u24 v90, 52429, v90
  v_lshrrev_b32 v90, 18, v90
  v_mul_u32_u24 v90, 640, v90
  v_sub_u32 v80, v80, v90
  v_cvt_f32_u32 v80, v80
  v_mov_b32 v90, 0x3acccccd
  v_fma_f32 v80, v80, v90, v93
  v_cos_f32 v80, v80
  s_nop 0
  v_mul_f32 v80, v80, v94
  v_add_u32 v96, 1, v95
  v_lshrrev_b32 v92, 1, v96
  v_mov_b32 v93, 0.25
  v_mov_b32 v94, 0x35cccccd
  v_cmp_ge_u32 vcc, 1, v96
  v_mov_b32 v97, 0x354ccccd
  s_nop 1
  v_cndmask_b32 v94, v94, v97, vcc
  v_mov_b32 v97, 320
  v_cndmask_b32 v92, v92, v97, vcc
  v_mov_b32 v97, 0
  v_cndmask_b32 v93, v93, v97, vcc
  v_mul_u32_u24 v81, v91, v92
  v_lshrrev_b32 v90, 7, v81
  v_mul_u32_u24 v90, 52429, v90
  v_lshrrev_b32 v90, 18, v90
  v_mul_u32_u24 v90, 640, v90
  v_sub_u32 v81, v81, v90
  v_cvt_f32_u32 v81, v81
  v_mov_b32 v90, 0x3acccccd
  v_fma_f32 v81, v81, v90, v93
  v_cos_f32 v81, v81
  s_nop 0
  v_mul_f32 v81, v81, v94
  v_add_u32 v96, 2, v95
  v_lshrrev_b32 v92, 1, v96
  v_mov_b32 v93, 0
  v_mov_b32 v94, 0x35cccccd
  v_mul_u32_u24 v82, v91, v92
  v_lshrrev_b32 v90, 7, v82
  v_mul_u32_u24 v90, 52429, v90
  v_lshrrev_b32 v90, 18, v90
  v_mul_u32_u24 v90, 640, v90
  v_sub_u32 v82, v82, v90
  v_cvt_f32_u32 v82, v82
  v_mov_b32 v90, 0x3acccccd
  v_fma_f32 v82, v82, v90, v93
  v_cos_f32 v82, v82
  s_nop 0
  v_mul_f32 v82, v82, v94
  v_add_u32 v96, 3, v95
  v_lshrrev_b32 v92, 1, v96
  v_mov_b32 v93, 0.25
  v_mov_b32 v94, 0x35cccccd
  v_mul_u32_u24 v83, v91, v92
  v_lshrrev_b32 v90, 7, v83
  v_mul_u32_u24 v90, 52429, v90
  v_lshrrev_b32 v90, 18, v90
  v_mul_u32_u24 v90, 640, v90
  v_sub_u32 v83, v83, v90
  v_cvt_f32_u32 v83, v83
  v_mov_b32 v90, 0x3acccccd
  v_fma_f32 v83, v83, v90, v93
  v_cos_f32 v83, v83
  s_nop 0
  v_mul_f32 v83, v83, v94
  v_add_u32 v96, 4, v95
  v_lshrrev_b32 v92, 1, v96
  v_mov_b32 v93, 0
  v_mov_b32 v94, 0x35cccccd
  v_mul_u32_u24 v84, v91, v92
  v_lshrrev_b32 v90, 7, v84
  v_mul_u32_u24 v90, 52429, v90
  v_lshrrev_b32 v90, 18, v90
  v_mul_u32_u24 v90, 640, v90
  v_sub_u32 v84, v84, v90
  v_cvt_f32_u32 v84, v84
  v_mov_b32 v90, 0x3acccccd
  v_fma_f32 v84, v84, v90, v93
  v_cos_f32 v84, v84
  s_nop 0
  v_mul_f32 v84, v84, v94
  v_add_u32 v96, 5, v95
  v_lshrrev_b32 v92, 1, v96
  v_mov_b32 v93, 0.25
  v_mov_b32 v94, 0x35cccccd
  v_mul_u32_u24 v85, v91, v92
  v_lshrrev_b32 v90, 7, v85
  v_mul_u32_u24 v90, 52429, v90
  v_lshrrev_b32 v90, 18, v90
  v_mul_u32_u24 v90, 640, v90
  v_sub_u32 v85, v85, v90
  v_cvt_f32_u32 v85, v85
  v_mov_b32 v90, 0x3acccccd
  v_fma_f32 v85, v85, v90, v93
  v_cos_f32 v85, v85
  s_nop 0
  v_mul_f32 v85, v85, v94
  v_add_u32 v96, 6, v95
  v_lshrrev_b32 v92, 1, v96
  v_mov_b32 v93, 0
  v_mov_b32 v94, 0x35cccccd
  v_mul_u32_u24 v86, v91, v92
  v_lshrrev_b32 v90, 7, v86
  v_mul_u32_u24 v90, 52429, v90
  v_lshrrev_b32 v90, 18, v90
  v_mul_u32_u24 v90, 640, v90
  v_sub_u32 v86, v86, v90
  v_cvt_f32_u32 v86, v86
  v_mov_b32 v90, 0x3acccccd
  v_fma_f32 v86, v86, v90, v93
  v_cos_f32 v86, v86
  s_nop 0
  v_mul_f32 v86, v86, v94
  v_add_u32 v96, 7, v95
  v_lshrrev_b32 v92, 1, v96
  v_mov_b32 v93, 0.25
  v_mov_b32 v94, 0x35cccccd
  v_mul_u32_u24 v87, v91, v92
  v_lshrrev_b32 v90, 7, v87
  v_mul_u32_u24 v90, 52429, v90
  v_lshrrev_b32 v90, 18, v90
  v_mul_u32_u24 v90, 640, v90
  v_sub_u32 v87, v87, v90
  v_cvt_f32_u32 v87, v87
  v_mov_b32 v90, 0x3acccccd
  v_fma_f32 v87, v87, v90, v93
  v_cos_f32 v87, v87
  s_nop 0
  v_mul_f32 v87, v87, v94
  v_cvt_pk_bf16_f32 v80, v80, v81
  v_cvt_pk_bf16_f32 v81, v82, v83
  v_cvt_pk_bf16_f32 v82, v84, v85
  v_cvt_pk_bf16_f32 v83, v86, v87
  s_branch tg_6
tg_4:
  s_sub_u32 s58, s56, 1600
  s_lshl_b32 s65, s58, 10
  s_add_u32 s65, s65, 17825792
  s_lshr_b32 s59, s58, 4
  s_bfe_u32 s60, s58, 0x10003
  s_bfe_u32 s61, s58, 0x20001
  s_and_b32 s62, s58, 1
  s_lshl_b32 s63, s60, 5
  s_cmp_eq_u32 s59, 0
  s_cselect_b32 s64, s63, 0
  s_cselect_b32 s66, 0, s63
  s_lshl_b32 s67, s61, 3
  s_add_u32 s64, s64, s67
  v_lshlrev_b32 v95, 2, v5
  v_add_u32 v95, s64, v95
  v_add_u32 v91, s66, v4
  s_cmp_eq_u32 s62, 0
  s_cselect_b32 s67, 0, 0xbe800000
  v_add_u32 v80, 0, v95
  v_mul_u32_u24 v80, v80, v91
  v_and_b32 v80, 2047, v80
  v_cvt_f32_u32 v80, v80
  v_mov_b32 v90, 0x3a000000
  v_fma_f32 v80, v80, v90, s67
  v_cos_f32 v80, v80
  v_add_u32 v81, 1, v95
  v_mul_u32_u24 v81, v81, v91
  v_and_b32 v81, 2047, v81
  v_cvt_f32_u32 v81, v81
  v_mov_b32 v90, 0x3a000000
  v_fma_f32 v81, v81, v90, s67
  v_cos_f32 v81, v81
  v_add_u32 v82, 2, v95
  v_mul_u32_u24 v82, v82, v91
  v_and_b32 v82, 2047, v82
  v_cvt_f32_u32 v82, v82
  v_mov_b32 v90, 0x3a000000
  v_fma_f32 v82, v82, v90, s67
  v_cos_f32 v82, v82
  v_add_u32 v83, 3, v95
  v_mul_u32_u24 v83, v83, v91
  v_and_b32 v83, 2047, v83
  v_cvt_f32_u32 v83, v83
  v_mov_b32 v90, 0x3a000000
  v_fma_f32 v83, v83, v90, s67
  v_cos_f32 v83, v83
  s_branch tg_6
tg_5:
  s_sub_u32 s58, s56, 1632
  s_lshl_b32 s65, s58, 10
  s_add_u32 s65, s65, 17858560
  s_mul_i32 s66, s58, 43
  s_lshr_b32 s66, s66, 8
  s_mul_i32 s59, s66, 6
  s_sub_u32 s58, s58, s59
  s_lshr_b32 s59, s58, 1
  s_and_b32 s60, s58, 1
  s_lshl_b32 s60, s60, 4
  s_cmp_eq_u32 s66, 0
  s_cselect_b32 s62, 31, 63
  s_mov_b32 s63, 0x3c800000
  s_cselect_b32 s63, 0x3d000000, s63
  s_cmp_eq_u32 s66, 1
  s_cselect_b32 s61, 1, 0
  s_cmp_eq_u32 s66, 2
  s_cselect_b32 s67, 1, 0
  s_cmp_eq_u32 s59, 1
  s_cselect_b32 s64, 0xbe800000, 0
  s_cmp_eq_u32 s59, 2
  s_cselect_b32 s64, 0x3e800000, s64
  v_lshlrev_b32 v91, s61, v4
  v_add_u32 v91, s61, v91
  v_lshlrev_b32 v95, 2, v5
  v_add_u32 v95, s60, v95
  v_mov_b32 v96, s63
  v_mov_b32 v97, s64
  v_add_u32 v80, 0, v95
  v_lshlrev_b32 v80, s67, v80
  v_add_u32 v80, s67, v80
  v_mul_u32_u24 v80, v80, v91
  v_and_b32 v80, s62, v80
  v_cvt_f32_u32 v80, v80
  v_fma_f32 v80, v80, v96, v97
  v_cos_f32 v80, v80
  v_add_u32 v81, 1, v95
  v_lshlrev_b32 v81, s67, v81
  v_add_u32 v81, s67, v81
  v_mul_u32_u24 v81, v81, v91
  v_and_b32 v81, s62, v81
  v_cvt_f32_u32 v81, v81
  v_fma_f32 v81, v81, v96, v97
  v_cos_f32 v81, v81
  v_add_u32 v82, 2, v95
  v_lshlrev_b32 v82, s67, v82
  v_add_u32 v82, s67, v82
  v_mul_u32_u24 v82, v82, v91
  v_and_b32 v82, s62, v82
  v_cvt_f32_u32 v82, v82
  v_fma_f32 v82, v82, v96, v97
  v_cos_f32 v82, v82
  v_add_u32 v83, 3, v95
  v_lshlrev_b32 v83, s67, v83
  v_add_u32 v83, s67, v83
  v_mul_u32_u24 v83, v83, v91
  v_and_b32 v83, s62, v83
  v_cvt_f32_u32 v83, v83
  v_fma_f32 v83, v83, v96, v97
  v_cos_f32 v83, v83
  v_add_u32 v84, 8, v95
  v_lshlrev_b32 v84, s67, v84
  v_add_u32 v84, s67, v84
  v_mul_u32_u24 v84, v84, v91
  v_and_b32 v84, s62, v84
  v_cvt_f32_u32 v84, v84
  v_fma_f32 v84, v84, v96, v97
  v_cos_f32 v84, v84
  v_add_u32 v85, 9, v95
  v_lshlrev_b32 v85, s67, v85
  v_add_u32 v85, s67, v85
  v_mul_u32_u24 v85, v85, v91
  v_and_b32 v85, s62, v85
  v_cvt_f32_u32 v85, v85
  v_fma_f32 v85, v85, v96, v97
  v_cos_f32 v85, v85
  v_add_u32 v86, 10, v95
  v_lshlrev_b32 v86, s67, v86
  v_add_u32 v86, s67, v86
  v_mul_u32_u24 v86, v86, v91
  v_and_b32 v86, s62, v86
  v_cvt_f32_u32 v86, v86
  v_fma_f32 v86, v86, v96, v97
  v_cos_f32 v86, v86
  v_add_u32 v87, 11, v95
  v_lshlrev_b32 v87, s67, v87
  v_add_u32 v87, s67, v87
  v_mul_u32_u24 v87, v87, v91
  v_and_b32 v87, s62, v87
  v_cvt_f32_u32 v87, v87
  v_fma_f32 v87, v87, v96, v97
  v_cos_f32 v87, v87
  s_nop 0
  v_cvt_pk_bf16_f32 v80, v80, v81
  v_cvt_pk_bf16_f32 v81, v82, v83
  v_cvt_pk_bf16_f32 v82, v84, v85
  v_cvt_pk_bf16_f32 v83, v86, v87
tg_6:
  s_mov_b32 s68, 1
tg_7:
  s_cmp_ge_u32 s3, 4
  s_cbranch_scc1 vb_8
  s_mul_i32 s76, s4, 163840
  s_add_u32 s76, s76, s81
  s_add_u32 m0, s53, 81920
  s_nop 0
  buffer_load_dwordx4 v113, s[16:19], s76 offen lds
  s_mul_i32 s76, s4, 163840
  s_add_u32 s76, s76, s81
  s_add_u32 m0, s53, 86016
  s_nop 0
  buffer_load_dwordx4 v114, s[16:19], s76 offen lds
  s_mul_i32 s76, s5, 163840
  s_add_u32 s76, s76, s81
  s_add_u32 m0, s53, 102400
  s_nop 0
  buffer_load_dwordx4 v113, s[16:19], s76 offen lds
  s_mul_i32 s76, s5, 163840
  s_add_u32 s76, s76, s81
  s_add_u32 m0, s53, 106496
  s_nop 0
  buffer_load_dwordx4 v114, s[16:19], s76 offen lds
  s_branch ve_9
vb_8:
  s_mul_i32 s76, s4, 163840
  s_add_u32 s76, s76, s81
  s_add_u32 m0, s53, 86016
  s_nop 0
  buffer_load_dwordx4 v113, s[16:19], s76 offen lds
  s_mul_i32 s76, s4, 163840
  s_add_u32 s76, s76, s81
  s_add_u32 m0, s53, 90112
  s_nop 0
  buffer_load_dwordx4 v114, s[16:19], s76 offen lds
  s_mul_i32 s76, s4, 163840
  s_add_u32 s76, s76, s81
  s_add_u32 m0, s53, 94208
  s_nop 0
  buffer_load_dwordx4 v39, s[16:19], s76 offen lds
  s_mul_i32 s76, s5, 163840
  s_add_u32 s76, s76, s81
  s_add_u32 m0, s53, 106496
  s_nop 0
  buffer_load_dwordx4 v113, s[16:19], s76 offen lds
  s_mul_i32 s76, s5, 163840
  s_add_u32 s76, s76, s81
  s_add_u32 m0, s53, 110592
  s_nop 0
  buffer_load_dwordx4 v114, s[16:19], s76 offen lds
  s_mul_i32 s76, s5, 163840
  s_add_u32 s76, s76, s81
  s_add_u32 m0, s53, 114688
  s_nop 0
  buffer_load_dwordx4 v39, s[16:19], s76 offen lds
ve_9:
  s_cmp_eq_u32 s68, 0
  s_cbranch_scc1 tst_10
  buffer_store_dwordx4 v[80:83], v14, s[8:11], s65 offen sc1
tst_10:
  s_waitcnt lgkmcnt(0)
  s_add_u32 s50, s50, 1
  s_cmp_ge_u32 s3, 4
  s_cbranch_scc1 vb_11
  s_waitcnt vmcnt(4)
  s_branch ve_12
vb_11:
  s_waitcnt vmcnt(6)
ve_12:
  s_barrier
  s_cmp_ge_u32 s3, 2
  s_cbranch_scc1 kv_13
  s_and_b32 s64, s49, 3
  v_and_b32 v90, 3, v2
  v_xor_b32 v90, v90, v3
  v_lshlrev_b32 v90, 4, v90
  v_lshl_add_u32 v90, v2, 8, v90
  s_lshl_b32 s56, s64, 12
  s_add_u32 s56, s56, 0
  v_add_u32 v90, s56, v90
  v_lshrrev_b32 v91, 2, v2
  v_xor_b32 v80, 0, v91
  v_lshl_add_u32 v80, v80, 6, v90
  v_xor_b32 v81, 1, v91
  v_lshl_add_u32 v81, v81, 6, v90
  v_xor_b32 v82, 2, v91
  v_lshl_add_u32 v82, v82, 6, v90
  v_xor_b32 v83, 3, v91
  v_lshl_add_u32 v83, v83, 6, v90
  v_add_u32 v84, 65536, v80
  v_add_u32 v85, 65536, v81
  v_add_u32 v86, 65536, v82
  v_add_u32 v87, 65536, v83
  v_lshrrev_b32 v90, 2, v2
  v_lshl_add_u32 v90, v3, 3, v90
  v_mul_u32_u24 v88, 40, v90
  v_and_b32 v90, 3, v2
  v_lshl_add_u32 v88, v90, 3, v88
  s_lshl_b32 s56, s3, 5
  s_add_u32 s56, s56, 122880
  v_add_u32 v88, s56, v88
  s_mul_i32 s56, s4, 5120
  v_add_u32 v96, s56, v88
  s_mul_i32 s56, s5, 5120
  v_add_u32 v97, s56, v88
  s_mul_i32 s56, s6, 5120
  v_add_u32 v98, s56, v88
  s_mul_i32 s56, s7, 5120
  v_add_u32 v99, s56, v88
  s_mul_i32 s56, s54, 5120
  v_add_u32 v100, s56, v88
  s_cmp_ge_u32 s49, 4
  s_cbranch_scc1 kv_14
  ds_read_b128 v[40:43], v80 offset:0
  ds_read_b64_tr_b16 v[44:45], v96 offset:0
  ds_read_b64_tr_b16 v[46:47], v96 offset:160
  ds_read_b128 v[48:51], v81 offset:0
  ds_read_b64_tr_b16 v[52:53], v96 offset:1280
  ds_read_b64_tr_b16 v[54:55], v96 offset:1440
  ds_read_b128 v[56:59], v82 offset:0
  ds_read_b64_tr_b16 v[60:61], v96 offset:2560
  ds_read_b64_tr_b16 v[62:63], v96 offset:2720
  ds_read_b128 v[64:67], v83 offset:0
  ds_read_b64_tr_b16 v[68:69], v96 offset:3840
  ds_read_b64_tr_b16 v[70:71], v96 offset:4000
  s_waitcnt lgkmcnt(9)
  v_mfma_f32_16x16x32_bf16 v[16:19], v[44:47], v[40:43], 0
  ds_read_b128 v[40:43], v80 offset:16384
  ds_read_b64_tr_b16 v[44:45], v97 offset:0
  ds_read_b64_tr_b16 v[46:47], v97 offset:160
  s_waitcnt lgkmcnt(9)
  v_mfma_f32_16x16x32_bf16 v[16:19], v[52:55], v[48:51], v[16:19]
  ds_read_b128 v[48:51], v81 offset:16384
  ds_read_b64_tr_b16 v[52:53], v97 offset:1280
  ds_read_b64_tr_b16 v[54:55], v97 offset:1440
  s_waitcnt lgkmcnt(9)
  v_mfma_f32_16x16x32_bf16 v[16:19], v[60:63], v[56:59], v[16:19]
  ds_read_b128 v[56:59], v82 offset:16384
  ds_read_b64_tr_b16 v[60:61], v97 offset:2560
  ds_read_b64_tr_b16 v[62:63], v97 offset:2720
  s_waitcnt lgkmcnt(9)
  v_mfma_f32_16x16x32_bf16 v[16:19], v[68:71], v[64:67], v[16:19]
  ds_read_b128 v[64:67], v83 offset:16384
  ds_read_b64_tr_b16 v[68:69], v97 offset:3840
  ds_read_b64_tr_b16 v[70:71], v97 offset:4000
  s_waitcnt lgkmcnt(9)
  v_mfma_f32_16x16x32_bf16 v[16:19], v[44:47], v[40:43], v[16:19]
  ds_read_b128 v[40:43], v80 offset:32768
  ds_read_b64_tr_b16 v[44:45], v98 offset:0
  ds_read_b64_tr_b16 v[46:47], v98 offset:160
  s_waitcnt lgkmcnt(9)
  v_mfma_f32_16x16x32_bf16 v[16:19], v[52:55], v[48:51], v[16:19]
  ds_read_b128 v[48:51], v81 offset:32768
  ds_read_b64_tr_b16 v[52:53], v98 offset:1280
  ds_read_b64_tr_b16 v[54:55], v98 offset:1440
  s_waitcnt lgkmcnt(9)
  v_mfma_f32_16x16x32_bf16 v[16:19], v[60:63], v[56:59], v[16:19]
  ds_read_b128 v[56:59], v82 offset:32768
  ds_read_b64_tr_b16 v[60:61], v98 offset:2560
  ds_read_b64_tr_b16 v[62:63], v98 offset:2720
  s_waitcnt lgkmcnt(9)
  v_mfma_f32_16x16x32_bf16 v[16:19], v[68:71], v[64:67], v[16:19]
  ds_read_b128 v[64:67], v83 offset:32768
  ds_read_b64_tr_b16 v[68:69], v98 offset:3840
  ds_read_b64_tr_b16 v[70:71], v98 offset:4000
  s_waitcnt lgkmcnt(9)
  v_mfma_f32_16x16x32_bf16 v[16:19], v[44:47], v[40:43], v[16:19]
  ds_read_b128 v[40:43], v80 offset:49152
  ds_read_b64_tr_b16 v[44:45], v99 offset:0
  ds_read_b64_tr_b16 v[46:47], v99 offset:160
  s_waitcnt lgkmcnt(9)
  v_mfma_f32_16x16x32_bf16 v[16:19], v[52:55], v[48:51], v[16:19]
  ds_read_b128 v[48:51], v81 offset:49152
  ds_read_b64_tr_b16 v[52:53], v99 offset:1280
  ds_read_b64_tr_b16 v[54:55], v99 offset:1440
  s_waitcnt lgkmcnt(9)
  v_mfma_f32_16x16x32_bf16 v[16:19], v[60:63], v[56:59], v[16:19]
  ds_read_b128 v[56:59], v82 offset:49152
  ds_read_b64_tr_b16 v[60:61], v99 offset:2560
  ds_read_b64_tr_b16 v[62:63], v99 offset:2720
  s_waitcnt lgkmcnt(9)
  v_mfma_f32_16x16x32_bf16 v[16:19], v[68:71], v[64:67], v[16:19]
  ds_read_b128 v[64:67], v83 offset:49152
  ds_read_b64_tr_b16 v[68:69], v99 offset:3840
  ds_read_b64_tr_b16 v[70:71], v99 offset:4000
  s_waitcnt lgkmcnt(9)
  v_mfma_f32_16x16x32_bf16 v[16:19], v[44:47], v[40:43], v[16:19]
  ds_read_b128 v[40:43], v84
  ds_read_b64_tr_b16 v[44:45], v100 offset:0
  ds_read_b64_tr_b16 v[46:47], v100 offset:160
  s_waitcnt lgkmcnt(9)
  v_mfma_f32_16x16x32_bf16 v[16:19], v[52:55], v[48:51], v[16:19]
  ds_read_b128 v[48:51], v85
  ds_read_b64_tr_b16 v[52:53], v100 offset:1280
  ds_read_b64_tr_b16 v[54:55], v100 offset:1440
  s_waitcnt lgkmcnt(9)
  v_mfma_f32_16x16x32_bf16 v[16:19], v[60:63], v[56:59], v[16:19]
  ds_read_b128 v[56:59], v86
  ds_read_b64_tr_b16 v[60:61], v100 offset:2560
  ds_read_b64_tr_b16 v[62:63], v100 offset:2720
  s_waitcnt lgkmcnt(9)
  v_mfma_f32_16x16x32_bf16 v[16:19], v[68:71], v[64:67], v[16:19]
  ds_read_b128 v[64:67], v87
  ds_read_b64_tr_b16 v[68:69], v100 offset:3840
  ds_read_b64_tr_b16 v[70:71], v100 offset:4000
  s_waitcnt lgkmcnt(9)
  v_mfma_f32_16x16x32_bf16 v[16:19], v[44:47], v[40:43], v[16:19]
  s_waitcnt lgkmcnt(6)
  v_mfma_f32_16x16x32_bf16 v[16:19], v[52:55], v[48:51], v[16:19]
  s_waitcnt lgkmcnt(3)
  v_mfma_f32_16x16x32_bf16 v[16:19], v[60:63], v[56:59], v[16:19]
  s_waitcnt lgkmcnt(0)
  v_mfma_f32_16x16x32_bf16 v[16:19], v[68:71], v[64:67], v[16:19]
  s_nop 7
  v_cvt_pk_bf16_f32 v16, v16, v17
  v_cvt_pk_bf16_f32 v17, v18, v19
  s_lshr_b32 s56, s64, 1
  s_lshl_b32 s57, s48, 1
  s_add_u32 s56, s56, s57
  s_and_b32 s57, s64, 1
  v_mov_b32 v91, 0x7fffffff
  s_cmp_eq_u32 s3, 1
  s_cbranch_scc1 kv_16
  s_mul_i32 s58, s56, 2880
  s_lshl_b32 s59, s57, 8
  s_add_u32 s58, s58, s59
  s_add_u32 s58, s58, 0
  v_lshrrev_b32 v92, 1, v3
  v_lshlrev_b32 v92, 9, v92
  v_lshl_add_u32 v92, v2, 4, v92
  v_and_b32 v93, 1, v3
  v_lshl_add_u32 v92, v93, 3, v92
  s_branch kv_17
kv_16:
  s_mul_i32 s58, s56, 2880
  s_lshl_b32 s59, s57, 7
  s_add_u32 s58, s58, s59
  s_add_u32 s58, s58, 1024
  v_lshlrev_b32 v92, 3, v2
  v_lshl_add_u32 v92, v3, 8, v92
  v_cmp_eq_u32 vcc, 1, v3
  v_mov_b32 v93, 0x3f803f80
  v_mov_b32 v94, 0x00003f80
  v_cndmask_b32 v16, v16, v93, vcc
  v_cndmask_b32 v17, v17, v94, vcc
  v_cmp_gt_u32 vcc, 2, v3
  s_nop 1
  v_cndmask_b32 v92, v91, v92, vcc
kv_17:
  buffer_store_dwordx2 v[16:17], v92, s[8:11], s58 offen sc1
  s_branch kv_13
kv_14:
  ds_read_b128 v[40:43], v80 offset:0
  ds_read_b64_tr_b16 v[44:45], v96 offset:0
  ds_read_b64_tr_b16 v[46:47], v96 offset:160
  ds_read_b128 v[48:51], v81 offset:0
  ds_read_b64_tr_b16 v[52:53], v96 offset:1280
  ds_read_b64_tr_b16 v[54:55], v96 offset:1440
  ds_read_b128 v[56:59], v82 offset:0
  ds_read_b64_tr_b16 v[60:61], v96 offset:2560
  ds_read_b64_tr_b16 v[62:63], v96 offset:2720
  ds_read_b128 v[64:67], v83 offset:0
  ds_read_b64_tr_b16 v[68:69], v96 offset:3840
  ds_read_b64_tr_b16 v[70:71], v96 offset:4000
  s_waitcnt lgkmcnt(9)
  v_mfma_f32_16x16x32_bf16 v[16:19], v[40:43], v[44:47], 0
  ds_read_b128 v[40:43], v80 offset:16384
  ds_read_b64_tr_b16 v[44:45], v97 offset:0
  ds_read_b64_tr_b16 v[46:47], v97 offset:160
  s_waitcnt lgkmcnt(9)
  v_mfma_f32_16x16x32_bf16 v[16:19], v[48:51], v[52:55], v[16:19]
  ds_read_b128 v[48:51], v81 offset:16384
  ds_read_b64_tr_b16 v[52:53], v97 offset:1280
  ds_read_b64_tr_b16 v[54:55], v97 offset:1440
  s_waitcnt lgkmcnt(9)
  v_mfma_f32_16x16x32_bf16 v[16:19], v[56:59], v[60:63], v[16:19]
  ds_read_b128 v[56:59], v82 offset:16384
  ds_read_b64_tr_b16 v[60:61], v97 offset:2560
  ds_read_b64_tr_b16 v[62:63], v97 offset:2720
  s_waitcnt lgkmcnt(9)
  v_mfma_f32_16x16x32_bf16 v[16:19], v[64:67], v[68:71], v[16:19]
  ds_read_b128 v[64:67], v83 offset:16384
  ds_read_b64_tr_b16 v[68:69], v97 offset:3840
  ds_read_b64_tr_b16 v[70:71], v97 offset:4000
  s_waitcnt lgkmcnt(9)
  v_mfma_f32_16x16x32_bf16 v[16:19], v[40:43], v[44:47], v[16:19]
  ds_read_b128 v[40:43], v80 offset:32768
  ds_read_b64_tr_b16 v[44:45], v98 offset:0
  ds_read_b64_tr_b16 v[46:47], v98 offset:160
  s_waitcnt lgkmcnt(9)
  v_mfma_f32_16x16x32_bf16 v[16:19], v[48:51], v[52:55], v[16:19]
  ds_read_b128 v[48:51], v81 offset:32768
  ds_read_b64_tr_b16 v[52:53], v98 offset:1280
  ds_read_b64_tr_b16 v[54:55], v98 offset:1440
  s_waitcnt lgkmcnt(9)
  v_mfma_f32_16x16x32_bf16 v[16:19], v[56:59], v[60:63], v[16:19]
  ds_read_b128 v[56:59], v82 offset:32768
  ds_read_b64_tr_b16 v[60:61], v98 offset:2560
  ds_read_b64_tr_b16 v[62:63], v98 offset:2720
  s_waitcnt lgkmcnt(9)
  v_mfma_f32_16x16x32_bf16 v[16:19], v[64:67], v[68:71], v[16:19]
  ds_read_b128 v[64:67], v83 offset:32768
  ds_read_b64_tr_b16 v[68:69], v98 offset:3840
  ds_read_b64_tr_b16 v[70:71], v98 offset:4000
  s_waitcnt lgkmcnt(9)
  v_mfma_f32_16x16x32_bf16 v[16:19], v[40:43], v[44:47], v[16:19]
  ds_read_b128 v[40:43], v80 offset:49152
  ds_read_b64_tr_b16 v[44:45], v99 offset:0
  ds_read_b64_tr_b16 v[46:47], v99 offset:160
  s_waitcnt lgkmcnt(9)
  v_mfma_f32_16x16x32_bf16 v[16:19], v[48:51], v[52:55], v[16:19]
  ds_read_b128 v[48:51], v81 offset:49152
  ds_read_b64_tr_b16 v[52:53], v99 offset:1280
  ds_read_b64_tr_b16 v[54:55], v99 offset:1440
  s_waitcnt lgkmcnt(9)
  v_mfma_f32_16x16x32_bf16 v[16:19], v[56:59], v[60:63], v[16:19]
  ds_read_b128 v[56:59], v82 offset:49152
  ds_read_b64_tr_b16 v[60:61], v99 offset:2560
  ds_read_b64_tr_b16 v[62:63], v99 offset:2720
  s_waitcnt lgkmcnt(9)
  v_mfma_f32_16x16x32_bf16 v[16:19], v[64:67], v[68:71], v[16:19]
  ds_read_b128 v[64:67], v83 offset:49152
  ds_read_b64_tr_b16 v[68:69], v99 offset:3840
  ds_read_b64_tr_b16 v[70:71], v99 offset:4000
  s_waitcnt lgkmcnt(9)
  v_mfma_f32_16x16x32_bf16 v[16:19], v[40:43], v[44:47], v[16:19]
  ds_read_b128 v[40:43], v84
  ds_read_b64_tr_b16 v[44:45], v100 offset:0
  ds_read_b64_tr_b16 v[46:47], v100 offset:160
  s_waitcnt lgkmcnt(9)
  v_mfma_f32_16x16x32_bf16 v[16:19], v[48:51], v[52:55], v[16:19]
  ds_read_b128 v[48:51], v85
  ds_read_b64_tr_b16 v[52:53], v100 offset:1280
  ds_read_b64_tr_b16 v[54:55], v100 offset:1440
  s_waitcnt lgkmcnt(9)
  v_mfma_f32_16x16x32_bf16 v[16:19], v[56:59], v[60:63], v[16:19]
  ds_read_b128 v[56:59], v86
  ds_read_b64_tr_b16 v[60:61], v100 offset:2560
  ds_read_b64_tr_b16 v[62:63], v100 offset:2720
  s_waitcnt lgkmcnt(9)
  v_mfma_f32_16x16x32_bf16 v[16:19], v[64:67], v[68:71], v[16:19]
  ds_read_b128 v[64:67], v87
  ds_read_b64_tr_b16 v[68:69], v100 offset:3840
  ds_read_b64_tr_b16 v[70:71], v100 offset:4000
  s_waitcnt lgkmcnt(9)
  v_mfma_f32_16x16x32_bf16 v[16:19], v[40:43], v[44:47], v[16:19]
  s_waitcnt lgkmcnt(6)
  v_mfma_f32_16x16x32_bf16 v[16:19], v[48:51], v[52:55], v[16:19]
  s_waitcnt lgkmcnt(3)
  v_mfma_f32_16x16x32_bf16 v[16:19], v[56:59], v[60:63], v[16:19]
  s_waitcnt lgkmcnt(0)
  v_mfma_f32_16x16x32_bf16 v[16:19], v[64:67], v[68:71], v[16:19]
  s_nop 7
  v_cvt_pk_bf16_f32 v16, v16, v17
  v_cvt_pk_bf16_f32 v17, v18, v19
  s_lshr_b32 s56, s64, 1
  s_lshl_b32 s57, s48, 1
  s_add_u32 s56, s56, s57
  s_and_b32 s57, s64, 1
  v_mov_b32 v91, 0x7fffffff
  s_mul_i32 s58, s56, 2880
  s_mul_i32 s59, s57, 672
  s_add_u32 s58, s58, s59
  s_add_u32 s58, s58, 1536
  s_lshl_b32 s59, s3, 4
  v_add_u32 v93, s59, v2
  v_and_b32 v94, 1, v3
  v_mul_u32_u24 v92, 336, v94
  v_lshl_add_u32 v92, v93, 4, v92
  v_lshrrev_b32 v94, 1, v3
  v_lshl_add_u32 v92, v94, 3, v92
  v_cmp_eq_u32 vcc, 20, v93
  v_mov_b32 v94, 0x3f803f80
  s_nop 0
  v_cndmask_b32 v16, v16, v94, vcc
  v_cndmask_b32 v17, v17, v94, vcc
  v_cmp_ge_u32 vcc, 20, v93
  s_nop 1
  v_cndmask_b32 v92, v91, v92, vcc
  buffer_store_dwordx2 v[16:17], v92, s[8:11], s58 offen sc1
  s_branch kv_13
kv_13:
  s_cmp_ge_u32 s3, 4
  s_cbranch_scc1 vb_18
  s_waitcnt vmcnt(2)
  s_barrier
  v_add_u32 v33, 0, v12
  ds_read_b128 v[40:43], v8 offset:0
  ds_read_b64_tr_b16 v[44:45], v33 offset:0
  ds_read_b64_tr_b16 v[46:47], v33 offset:1280
  ds_read_b64_tr_b16 v[48:49], v33 offset:32
  ds_read_b64_tr_b16 v[50:51], v33 offset:1312
  ds_read_b64_tr_b16 v[52:53], v33 offset:64
  ds_read_b64_tr_b16 v[54:55], v33 offset:1344
  ds_read_b128 v[60:63], v9 offset:0
  ds_read_b64_tr_b16 v[64:65], v33 offset:5120
  ds_read_b64_tr_b16 v[66:67], v33 offset:6400
  ds_read_b64_tr_b16 v[68:69], v33 offset:5152
  ds_read_b64_tr_b16 v[70:71], v33 offset:6432
  ds_read_b64_tr_b16 v[72:73], v33 offset:5184
  ds_read_b64_tr_b16 v[74:75], v33 offset:6464
  s_mul_i32 s76, s6, 163840
  s_add_u32 s76, s76, s81
  s_add_u32 m0, s53, 122880
  s_nop 0
  buffer_load_dwordx4 v113, s[16:19], s76 offen lds
  s_waitcnt lgkmcnt(7)
  v_mfma_f32_16x16x32_bf16 v[16:19], v[44:47], v[40:43], 0
  v_mfma_f32_16x16x32_bf16 v[20:23], v[48:51], v[40:43], 0
  v_mfma_f32_16x16x32_bf16 v[24:27], v[52:55], v[40:43], 0
  ds_read_b128 v[40:43], v10 offset:0
  ds_read_b64_tr_b16 v[44:45], v33 offset:10240
  ds_read_b64_tr_b16 v[46:47], v33 offset:11520
  ds_read_b64_tr_b16 v[48:49], v33 offset:10272
  ds_read_b64_tr_b16 v[50:51], v33 offset:11552
  ds_read_b64_tr_b16 v[52:53], v33 offset:10304
  ds_read_b64_tr_b16 v[54:55], v33 offset:11584
  s_mul_i32 s76, s6, 163840
  s_add_u32 s76, s76, s81
  s_add_u32 m0, s53, 126976
  s_nop 0
  buffer_load_dwordx4 v114, s[16:19], s76 offen lds
  s_waitcnt lgkmcnt(7)
  v_mfma_f32_16x16x32_bf16 v[16:19], v[64:67], v[60:63], v[16:19]
  v_mfma_f32_16x16x32_bf16 v[20:23], v[68:71], v[60:63], v[20:23]
  v_mfma_f32_16x16x32_bf16 v[24:27], v[72:75], v[60:63], v[24:27]
  ds_read_b128 v[60:63], v11 offset:0
  ds_read_b64_tr_b16 v[64:65], v33 offset:15360
  ds_read_b64_tr_b16 v[66:67], v33 offset:16640
  ds_read_b64_tr_b16 v[68:69], v33 offset:15392
  ds_read_b64_tr_b16 v[70:71], v33 offset:16672
  ds_read_b64_tr_b16 v[72:73], v33 offset:15424
  ds_read_b64_tr_b16 v[74:75], v33 offset:16704
  s_waitcnt lgkmcnt(7)
  v_mfma_f32_16x16x32_bf16 v[16:19], v[44:47], v[40:43], v[16:19]
  v_mfma_f32_16x16x32_bf16 v[20:23], v[48:51], v[40:43], v[20:23]
  v_mfma_f32_16x16x32_bf16 v[24:27], v[52:55], v[40:43], v[24:27]
  s_waitcnt lgkmcnt(0)
  v_mfma_f32_16x16x32_bf16 v[16:19], v[64:67], v[60:63], v[16:19]
  v_mfma_f32_16x16x32_bf16 v[20:23], v[68:71], v[60:63], v[20:23]
  v_mfma_f32_16x16x32_bf16 v[24:27], v[72:75], v[60:63], v[24:27]
  s_branch ve_19
vb_18:
  s_waitcnt vmcnt(3)
  s_barrier
  v_add_u32 v33, 0, v12
  s_mul_i32 s56, s4, 256
  v_add_u32 v36, s56, v115
  ds_read_b128 v[40:43], v8 offset:0
  ds_read_b64_tr_b16 v[44:45], v33 offset:96
  ds_read_b64_tr_b16 v[46:47], v33 offset:1376
  ds_read_b64_tr_b16 v[48:49], v33 offset:128
  ds_read_b64_tr_b16 v[50:51], v33 offset:1408
  ds_read_b128 v[52:55], v36 offset:0
  ds_read_b128 v[60:63], v9 offset:0
  ds_read_b64_tr_b16 v[64:65], v33 offset:5216
  ds_read_b64_tr_b16 v[66:67], v33 offset:6496
  ds_read_b64_tr_b16 v[68:69], v33 offset:5248
  ds_read_b64_tr_b16 v[70:71], v33 offset:6528
  ds_read_b128 v[72:75], v36 offset:64
  s_mul_i32 s76, s6, 163840
  s_add_u32 s76, s76, s81
  s_add_u32 m0, s53, 126976
  s_nop 0
  buffer_load_dwordx4 v113, s[16:19], s76 offen lds
  s_waitcnt lgkmcnt(6)
  v_mfma_f32_16x16x32_bf16 v[16:19], v[44:47], v[40:43], 0
  v_mfma_f32_16x16x32_bf16 v[20:23], v[48:51], v[40:43], 0
  v_mfma_f32_16x16x32_bf16 v[24:27], v[52:55], v[40:43], 0
  ds_read_b128 v[40:43], v10 offset:0
  ds_read_b64_tr_b16 v[44:45], v33 offset:10336
  ds_read_b64_tr_b16 v[46:47], v33 offset:11616
  ds_read_b64_tr_b16 v[48:49], v33 offset:10368
  ds_read_b64_tr_b16 v[50:51], v33 offset:11648
  ds_read_b128 v[52:55], v36 offset:128
  s_mul_i32 s76, s6, 163840
  s_add_u32 s76, s76, s81
  s_add_u32 m0, s53, 131072
  s_nop 0
  buffer_load_dwordx4 v114, s[16:19], s76 offen lds
  s_waitcnt lgkmcnt(6)
  v_mfma_f32_16x16x32_bf16 v[16:19], v[64:67], v[60:63], v[16:19]
  v_mfma_f32_16x16x32_bf16 v[20:23], v[68:71], v[60:63], v[20:23]
  v_mfma_f32_16x16x32_bf16 v[24:27], v[72:75], v[60:63], v[24:27]
  ds_read_b128 v[60:63], v11 offset:0
  ds_read_b64_tr_b16 v[64:65], v33 offset:15456
  ds_read_b64_tr_b16 v[66:67], v33 offset:16736
  ds_read_b64_tr_b16 v[68:69], v33 offset:15488
  ds_read_b64_tr_b16 v[70:71], v33 offset:16768
  ds_read_b128 v[72:75], v36 offset:192
  s_mul_i32 s76, s6, 163840
  s_add_u32 s76, s76, s81
  s_add_u32 m0, s53, 135168
  s_nop 0
  buffer_load_dwordx4 v39, s[16:19], s76 offen lds
  s_waitcnt lgkmcnt(6)
  v_mfma_f32_16x16x32_bf16 v[16:19], v[44:47], v[40:43], v[16:19]
  v_mfma_f32_16x16x32_bf16 v[20:23], v[48:51], v[40:43], v[20:23]
  v_mfma_f32_16x16x32_bf16 v[24:27], v[52:55], v[40:43], v[24:27]
  s_waitcnt lgkmcnt(0)
  v_mfma_f32_16x16x32_bf16 v[16:19], v[64:67], v[60:63], v[16:19]
  v_mfma_f32_16x16x32_bf16 v[20:23], v[68:71], v[60:63], v[20:23]
  v_mfma_f32_16x16x32_bf16 v[24:27], v[72:75], v[60:63], v[24:27]
ve_19:
  s_cmp_ge_u32 s3, 4
  s_cbranch_scc1 vb_20
  s_waitcnt vmcnt(2)
  s_barrier
  v_add_u32 v33, 20480, v12
  ds_read_b128 v[40:43], v8 offset:16384
  ds_read_b64_tr_b16 v[44:45], v33 offset:0
  ds_read_b64_tr_b16 v[46:47], v33 offset:1280
  ds_read_b64_tr_b16 v[48:49], v33 offset:32
  ds_read_b64_tr_b16 v[50:51], v33 offset:1312
  ds_read_b64_tr_b16 v[52:53], v33 offset:64
  ds_read_b64_tr_b16 v[54:55], v33 offset:1344
  ds_read_b128 v[60:63], v9 offset:16384
  ds_read_b64_tr_b16 v[64:65], v33 offset:5120
  ds_read_b64_tr_b16 v[66:67], v33 offset:6400
  ds_read_b64_tr_b16 v[68:69], v33 offset:5152
  ds_read_b64_tr_b16 v[70:71], v33 offset:6432
  ds_read_b64_tr_b16 v[72:73], v33 offset:5184
  ds_read_b64_tr_b16 v[74:75], v33 offset:6464
  s_mul_i32 s76, s7, 163840
  s_add_u32 s76, s76, s81
  s_add_u32 m0, s53, 81920
  s_nop 0
  buffer_load_dwordx4 v113, s[16:19], s76 offen lds
  s_waitcnt lgkmcnt(7)
  v_mfma_f32_16x16x32_bf16 v[16:19], v[44:47], v[40:43], v[16:19]
  v_mfma_f32_16x16x32_bf16 v[20:23], v[48:51], v[40:43], v[20:23]
  v_mfma_f32_16x16x32_bf16 v[24:27], v[52:55], v[40:43], v[24:27]
  ds_read_b128 v[40:43], v10 offset:16384
  ds_read_b64_tr_b16 v[44:45], v33 offset:10240
  ds_read_b64_tr_b16 v[46:47], v33 offset:11520
  ds_read_b64_tr_b16 v[48:49], v33 offset:10272
  ds_read_b64_tr_b16 v[50:51], v33 offset:11552
  ds_read_b64_tr_b16 v[52:53], v33 offset:10304
  ds_read_b64_tr_b16 v[54:55], v33 offset:11584
  s_mul_i32 s76, s7, 163840
  s_add_u32 s76, s76, s81
  s_add_u32 m0, s53, 86016
  s_nop 0
  buffer_load_dwordx4 v114, s[16:19], s76 offen lds
  s_waitcnt lgkmcnt(7)
  v_mfma_f32_16x16x32_bf16 v[16:19], v[64:67], v[60:63], v[16:19]
  v_mfma_f32_16x16x32_bf16 v[20:23], v[68:71], v[60:63], v[20:23]
  v_mfma_f32_16x16x32_bf16 v[24:27], v[72:75], v[60:63], v[24:27]
  ds_read_b128 v[60:63], v11 offset:16384
  ds_read_b64_tr_b16 v[64:65], v33 offset:15360
  ds_read_b64_tr_b16 v[66:67], v33 offset:16640
  ds_read_b64_tr_b16 v[68:69], v33 offset:15392
  ds_read_b64_tr_b16 v[70:71], v33 offset:16672
  ds_read_b64_tr_b16 v[72:73], v33 offset:15424
  ds_read_b64_tr_b16 v[74:75], v33 offset:16704
  s_waitcnt lgkmcnt(7)
  v_mfma_f32_16x16x32_bf16 v[16:19], v[44:47], v[40:43], v[16:19]
  v_mfma_f32_16x16x32_bf16 v[20:23], v[48:51], v[40:43], v[20:23]
  v_mfma_f32_16x16x32_bf16 v[24:27], v[52:55], v[40:43], v[24:27]
  s_waitcnt lgkmcnt(0)
  v_mfma_f32_16x16x32_bf16 v[16:19], v[64:67], v[60:63], v[16:19]
  v_mfma_f32_16x16x32_bf16 v[20:23], v[68:71], v[60:63], v[20:23]
  v_mfma_f32_16x16x32_bf16 v[24:27], v[72:75], v[60:63], v[24:27]
  s_branch ve_21
vb_20:
  s_waitcnt vmcnt(3)
  s_barrier
  v_add_u32 v33, 20480, v12
  s_mul_i32 s56, s5, 256
  v_add_u32 v36, s56, v115
  ds_read_b128 v[40:43], v8 offset:16384
  ds_read_b64_tr_b16 v[44:45], v33 offset:96
  ds_read_b64_tr_b16 v[46:47], v33 offset:1376
  ds_read_b64_tr_b16 v[48:49], v33 offset:128
  ds_read_b64_tr_b16 v[50:51], v33 offset:1408
  ds_read_b128 v[52:55], v36 offset:0
  ds_read_b128 v[60:63], v9 offset:16384
  ds_read_b64_tr_b16 v[64:65], v33 offset:5216
  ds_read_b64_tr_b16 v[66:67], v33 offset:6496
  ds_read_b64_tr_b16 v[68:69], v33 offset:5248
  ds_read_b64_tr_b16 v[70:71], v33 offset:6528
  ds_read_b128 v[72:75], v36 offset:64
  s_cmp_lg_u32 s3, 6
  s_cbranch_scc1 ow_22
  s_lshl_b32 s86, s2, 6
  s_add_u32 s86, s86, 18038784
  v_mov_b32 v15, s50
  s_mov_b64 s[88:89], exec
  s_mov_b64 exec, 1
  buffer_store_dword v15, off, s[8:11], s86 sc1
  s_mov_b64 exec, s[88:89]
ow_22:
  s_cmp_lg_u32 s3, 5
  s_cbranch_scc1 ow_23
  s_lshl_b32 s86, s2, 6
  s_add_u32 s86, s86, 18022400
  v_mov_b32 v15, s50
  s_mov_b64 s[88:89], exec
  s_mov_b64 exec, 1
  buffer_store_dword v15, off, s[8:11], s86 sc1
  s_mov_b64 exec, s[88:89]
ow_23:
  s_mul_i32 s76, s7, 163840
  s_add_u32 s76, s76, s81
  s_add_u32 m0, s53, 86016
  s_nop 0
  buffer_load_dwordx4 v113, s[16:19], s76 offen lds
  s_waitcnt lgkmcnt(6)
  v_mfma_f32_16x16x32_bf16 v[16:19], v[44:47], v[40:43], v[16:19]
  v_mfma_f32_16x16x32_bf16 v[20:23], v[48:51], v[40:43], v[20:23]
  v_mfma_f32_16x16x32_bf16 v[24:27], v[52:55], v[40:43], v[24:27]
  ds_read_b128 v[40:43], v10 offset:16384
  ds_read_b64_tr_b16 v[44:45], v33 offset:10336
  ds_read_b64_tr_b16 v[46:47], v33 offset:11616
  ds_read_b64_tr_b16 v[48:49], v33 offset:10368
  ds_read_b64_tr_b16 v[50:51], v33 offset:11648
  ds_read_b128 v[52:55], v36 offset:128
  s_mul_i32 s76, s7, 163840
  s_add_u32 s76, s76, s81
  s_add_u32 m0, s53, 90112
  s_nop 0
  buffer_load_dwordx4 v114, s[16:19], s76 offen lds
  s_waitcnt lgkmcnt(6)
  v_mfma_f32_16x16x32_bf16 v[16:19], v[64:67], v[60:63], v[16:19]
  v_mfma_f32_16x16x32_bf16 v[20:23], v[68:71], v[60:63], v[20:23]
  v_mfma_f32_16x16x32_bf16 v[24:27], v[72:75], v[60:63], v[24:27]
  ds_read_b128 v[60:63], v11 offset:16384
  ds_read_b64_tr_b16 v[64:65], v33 offset:15456
  ds_read_b64_tr_b16 v[66:67], v33 offset:16736
  ds_read_b64_tr_b16 v[68:69], v33 offset:15488
  ds_read_b64_tr_b16 v[70:71], v33 offset:16768
  ds_read_b128 v[72:75], v36 offset:192
  s_mul_i32 s76, s7, 163840
  s_add_u32 s76, s76, s81
  s_add_u32 m0, s53, 94208
  s_nop 0
  buffer_load_dwordx4 v39, s[16:19], s76 offen lds
  s_waitcnt lgkmcnt(6)
  v_mfma_f32_16x16x32_bf16 v[16:19], v[44:47], v[40:43], v[16:19]
  v_mfma_f32_16x16x32_bf16 v[20:23], v[48:51], v[40:43], v[20:23]
  v_mfma_f32_16x16x32_bf16 v[24:27], v[52:55], v[40:43], v[24:27]
  s_waitcnt lgkmcnt(0)
  v_mfma_f32_16x16x32_bf16 v[16:19], v[64:67], v[60:63], v[16:19]
  v_mfma_f32_16x16x32_bf16 v[20:23], v[68:71], v[60:63], v[20:23]
  v_mfma_f32_16x16x32_bf16 v[24:27], v[72:75], v[60:63], v[24:27]
ve_21:
  s_cmp_ge_u32 s3, 4
  s_cbranch_scc1 vb_24
  s_waitcnt vmcnt(2)
  s_barrier
  v_add_u32 v33, 40960, v12
  ds_read_b128 v[40:43], v8 offset:32768
  ds_read_b64_tr_b16 v[44:45], v33 offset:0
  ds_read_b64_tr_b16 v[46:47], v33 offset:1280
  ds_read_b64_tr_b16 v[48:49], v33 offset:32
  ds_read_b64_tr_b16 v[50:51], v33 offset:1312
  ds_read_b64_tr_b16 v[52:53], v33 offset:64
  ds_read_b64_tr_b16 v[54:55], v33 offset:1344
  ds_read_b128 v[60:63], v9 offset:32768
  ds_read_b64_tr_b16 v[64:65], v33 offset:5120
  ds_read_b64_tr_b16 v[66:67], v33 offset:6400
  ds_read_b64_tr_b16 v[68:69], v33 offset:5152
  ds_read_b64_tr_b16 v[70:71], v33 offset:6432
  ds_read_b64_tr_b16 v[72:73], v33 offset:5184
  ds_read_b64_tr_b16 v[74:75], v33 offset:6464
  s_mul_i32 s76, s54, 163840
  s_add_u32 s76, s76, s81
  s_add_u32 m0, s53, 102400
  s_nop 0
  buffer_load_dwordx4 v113, s[16:19], s76 offen lds
  s_waitcnt lgkmcnt(7)
  v_mfma_f32_16x16x32_bf16 v[16:19], v[44:47], v[40:43], v[16:19]
  v_mfma_f32_16x16x32_bf16 v[20:23], v[48:51], v[40:43], v[20:23]
  v_mfma_f32_16x16x32_bf16 v[24:27], v[52:55], v[40:43], v[24:27]
  ds_read_b128 v[40:43], v10 offset:32768
  ds_read_b64_tr_b16 v[44:45], v33 offset:10240
  ds_read_b64_tr_b16 v[46:47], v33 offset:11520
  ds_read_b64_tr_b16 v[48:49], v33 offset:10272
  ds_read_b64_tr_b16 v[50:51], v33 offset:11552
  ds_read_b64_tr_b16 v[52:53], v33 offset:10304
  ds_read_b64_tr_b16 v[54:55], v33 offset:11584
  s_mul_i32 s76, s54, 163840
  s_add_u32 s76, s76, s81
  s_add_u32 m0, s53, 106496
  s_nop 0
  buffer_load_dwordx4 v114, s[16:19], s76 offen lds
  s_waitcnt lgkmcnt(7)
  v_mfma_f32_16x16x32_bf16 v[16:19], v[64:67], v[60:63], v[16:19]
  v_mfma_f32_16x16x32_bf16 v[20:23], v[68:71], v[60:63], v[20:23]
  v_mfma_f32_16x16x32_bf16 v[24:27], v[72:75], v[60:63], v[24:27]
  ds_read_b128 v[60:63], v11 offset:32768
  ds_read_b64_tr_b16 v[64:65], v33 offset:15360
  ds_read_b64_tr_b16 v[66:67], v33 offset:16640
  ds_read_b64_tr_b16 v[68:69], v33 offset:15392
  ds_read_b64_tr_b16 v[70:71], v33 offset:16672
  ds_read_b64_tr_b16 v[72:73], v33 offset:15424
  ds_read_b64_tr_b16 v[74:75], v33 offset:16704
  s_waitcnt lgkmcnt(7)
  v_mfma_f32_16x16x32_bf16 v[16:19], v[44:47], v[40:43], v[16:19]
  v_mfma_f32_16x16x32_bf16 v[20:23], v[48:51], v[40:43], v[20:23]
  v_mfma_f32_16x16x32_bf16 v[24:27], v[52:55], v[40:43], v[24:27]
  s_waitcnt lgkmcnt(0)
  v_mfma_f32_16x16x32_bf16 v[16:19], v[64:67], v[60:63], v[16:19]
  v_mfma_f32_16x16x32_bf16 v[20:23], v[68:71], v[60:63], v[20:23]
  v_mfma_f32_16x16x32_bf16 v[24:27], v[72:75], v[60:63], v[24:27]
  s_branch ve_25
vb_24:
  s_waitcnt vmcnt(3)
  s_barrier
  v_add_u32 v33, 40960, v12
  s_mul_i32 s56, s6, 256
  v_add_u32 v36, s56, v115
  ds_read_b128 v[40:43], v8 offset:32768
  ds_read_b64_tr_b16 v[44:45], v33 offset:96
  ds_read_b64_tr_b16 v[46:47], v33 offset:1376
  ds_read_b64_tr_b16 v[48:49], v33 offset:128
  ds_read_b64_tr_b16 v[50:51], v33 offset:1408
  ds_read_b128 v[52:55], v36 offset:0
  ds_read_b128 v[60:63], v9 offset:32768
  ds_read_b64_tr_b16 v[64:65], v33 offset:5216
  ds_read_b64_tr_b16 v[66:67], v33 offset:6496
  ds_read_b64_tr_b16 v[68:69], v33 offset:5248
  ds_read_b64_tr_b16 v[70:71], v33 offset:6528
  ds_read_b128 v[72:75], v36 offset:64
  s_mul_i32 s76, s54, 163840
  s_add_u32 s76, s76, s81
  s_add_u32 m0, s53, 106496
  s_nop 0
  buffer_load_dwordx4 v113, s[16:19], s76 offen lds
  s_waitcnt lgkmcnt(6)
  v_mfma_f32_16x16x32_bf16 v[16:19], v[44:47], v[40:43], v[16:19]
  v_mfma_f32_16x16x32_bf16 v[20:23], v[48:51], v[40:43], v[20:23]
  v_mfma_f32_16x16x32_bf16 v[24:27], v[52:55], v[40:43], v[24:27]
  ds_read_b128 v[40:43], v10 offset:32768
  ds_read_b64_tr_b16 v[44:45], v33 offset:10336
  ds_read_b64_tr_b16 v[46:47], v33 offset:11616
  ds_read_b64_tr_b16 v[48:49], v33 offset:10368
  ds_read_b64_tr_b16 v[50:51], v33 offset:11648
  ds_read_b128 v[52:55], v36 offset:128
  s_mul_i32 s76, s54, 163840
  s_add_u32 s76, s76, s81
  s_add_u32 m0, s53, 110592
  s_nop 0
  buffer_load_dwordx4 v114, s[16:19], s76 offen lds
  s_waitcnt lgkmcnt(6)
  v_mfma_f32_16x16x32_bf16 v[16:19], v[64:67], v[60:63], v[16:19]
  v_mfma_f32_16x16x32_bf16 v[20:23], v[68:71], v[60:63], v[20:23]
  v_mfma_f32_16x16x32_bf16 v[24:27], v[72:75], v[60:63], v[24:27]
  ds_read_b128 v[60:63], v11 offset:32768
  ds_read_b64_tr_b16 v[64:65], v33 offset:15456
  ds_read_b64_tr_b16 v[66:67], v33 offset:16736
  ds_read_b64_tr_b16 v[68:69], v33 offset:15488
  ds_read_b64_tr_b16 v[70:71], v33 offset:16768
  ds_read_b128 v[72:75], v36 offset:192
  s_mul_i32 s76, s54, 163840
  s_add_u32 s76, s76, s81
  s_add_u32 m0, s53, 114688
  s_nop 0
  buffer_load_dwordx4 v39, s[16:19], s76 offen lds
  s_waitcnt lgkmcnt(6)
  v_mfma_f32_16x16x32_bf16 v[16:19], v[44:47], v[40:43], v[16:19]
  v_mfma_f32_16x16x32_bf16 v[20:23], v[48:51], v[40:43], v[20:23]
  v_mfma_f32_16x16x32_bf16 v[24:27], v[52:55], v[40:43], v[24:27]
  s_waitcnt lgkmcnt(0)
  v_mfma_f32_16x16x32_bf16 v[16:19], v[64:67], v[60:63], v[16:19]
  v_mfma_f32_16x16x32_bf16 v[20:23], v[68:71], v[60:63], v[20:23]
  v_mfma_f32_16x16x32_bf16 v[24:27], v[72:75], v[60:63], v[24:27]
ve_25:
  s_cmp_ge_u32 s3, 4
  s_cbranch_scc1 vb_26
  s_waitcnt vmcnt(2)
  s_barrier
  v_add_u32 v33, 0, v12
  ds_read_b128 v[40:43], v8 offset:49152
  ds_read_b64_tr_b16 v[44:45], v33 offset:0
  ds_read_b64_tr_b16 v[46:47], v33 offset:1280
  ds_read_b64_tr_b16 v[48:49], v33 offset:32
  ds_read_b64_tr_b16 v[50:51], v33 offset:1312
  ds_read_b64_tr_b16 v[52:53], v33 offset:64
  ds_read_b64_tr_b16 v[54:55], v33 offset:1344
  ds_read_b128 v[60:63], v9 offset:49152
  ds_read_b64_tr_b16 v[64:65], v33 offset:5120
  ds_read_b64_tr_b16 v[66:67], v33 offset:6400
  ds_read_b64_tr_b16 v[68:69], v33 offset:5152
  ds_read_b64_tr_b16 v[70:71], v33 offset:6432
  ds_read_b64_tr_b16 v[72:73], v33 offset:5184
  ds_read_b64_tr_b16 v[74:75], v33 offset:6464
  s_waitcnt lgkmcnt(7)
  v_mfma_f32_16x16x32_bf16 v[16:19], v[44:47], v[40:43], v[16:19]
  v_mfma_f32_16x16x32_bf16 v[20:23], v[48:51], v[40:43], v[20:23]
  v_mfma_f32_16x16x32_bf16 v[24:27], v[52:55], v[40:43], v[24:27]
  ds_read_b128 v[40:43], v10 offset:49152
  ds_read_b64_tr_b16 v[44:45], v33 offset:10240
  ds_read_b64_tr_b16 v[46:47], v33 offset:11520
  ds_read_b64_tr_b16 v[48:49], v33 offset:10272
  ds_read_b64_tr_b16 v[50:51], v33 offset:11552
  ds_read_b64_tr_b16 v[52:53], v33 offset:10304
  ds_read_b64_tr_b16 v[54:55], v33 offset:11584
  s_waitcnt lgkmcnt(7)
  v_mfma_f32_16x16x32_bf16 v[16:19], v[64:67], v[60:63], v[16:19]
  v_mfma_f32_16x16x32_bf16 v[20:23], v[68:71], v[60:63], v[20:23]
  v_mfma_f32_16x16x32_bf16 v[24:27], v[72:75], v[60:63], v[24:27]
  ds_read_b128 v[60:63], v11 offset:49152
  ds_read_b64_tr_b16 v[64:65], v33 offset:15360
  ds_read_b64_tr_b16 v[66:67], v33 offset:16640
  ds_read_b64_tr_b16 v[68:69], v33 offset:15392
  ds_read_b64_tr_b16 v[70:71], v33 offset:16672
  ds_read_b64_tr_b16 v[72:73], v33 offset:15424
  ds_read_b64_tr_b16 v[74:75], v33 offset:16704
  s_waitcnt lgkmcnt(7)
  v_mfma_f32_16x16x32_bf16 v[16:19], v[44:47], v[40:43], v[16:19]
  v_mfma_f32_16x16x32_bf16 v[20:23], v[48:51], v[40:43], v[20:23]
  v_mfma_f32_16x16x32_bf16 v[24:27], v[52:55], v[40:43], v[24:27]
  s_waitcnt lgkmcnt(0)
  v_mfma_f32_16x16x32_bf16 v[16:19], v[64:67], v[60:63], v[16:19]
  v_mfma_f32_16x16x32_bf16 v[20:23], v[68:71], v[60:63], v[20:23]
  v_mfma_f32_16x16x32_bf16 v[24:27], v[72:75], v[60:63], v[24:27]
  s_branch ve_27
vb_26:
  s_waitcnt vmcnt(3)
  s_barrier
  v_add_u32 v33, 0, v12
  s_mul_i32 s56, s7, 256
  v_add_u32 v36, s56, v115
  ds_read_b128 v[40:43], v8 offset:49152
  ds_read_b64_tr_b16 v[44:45], v33 offset:96
  ds_read_b64_tr_b16 v[46:47], v33 offset:1376
  ds_read_b64_tr_b16 v[48:49], v33 offset:128
  ds_read_b64_tr_b16 v[50:51], v33 offset:1408
  ds_read_b128 v[52:55], v36 offset:0
  ds_read_b128 v[60:63], v9 offset:49152
  ds_read_b64_tr_b16 v[64:65], v33 offset:5216
  ds_read_b64_tr_b16 v[66:67], v33 offset:6496
  ds_read_b64_tr_b16 v[68:69], v33 offset:5248
  ds_read_b64_tr_b16 v[70:71], v33 offset:6528
  ds_read_b128 v[72:75], v36 offset:64
  s_waitcnt lgkmcnt(6)
  v_mfma_f32_16x16x32_bf16 v[16:19], v[44:47], v[40:43], v[16:19]
  v_mfma_f32_16x16x32_bf16 v[20:23], v[48:51], v[40:43], v[20:23]
  v_mfma_f32_16x16x32_bf16 v[24:27], v[52:55], v[40:43], v[24:27]
  ds_read_b128 v[40:43], v10 offset:49152
  ds_read_b64_tr_b16 v[44:45], v33 offset:10336
  ds_read_b64_tr_b16 v[46:47], v33 offset:11616
  ds_read_b64_tr_b16 v[48:49], v33 offset:10368
  ds_read_b64_tr_b16 v[50:51], v33 offset:11648
  ds_read_b128 v[52:55], v36 offset:128
  s_waitcnt lgkmcnt(6)
  v_mfma_f32_16x16x32_bf16 v[16:19], v[64:67], v[60:63], v[16:19]
  v_mfma_f32_16x16x32_bf16 v[20:23], v[68:71], v[60:63], v[20:23]
  v_mfma_f32_16x16x32_bf16 v[24:27], v[72:75], v[60:63], v[24:27]
  ds_read_b128 v[60:63], v11 offset:49152
  ds_read_b64_tr_b16 v[64:65], v33 offset:15456
  ds_read_b64_tr_b16 v[66:67], v33 offset:16736
  ds_read_b64_tr_b16 v[68:69], v33 offset:15488
  ds_read_b64_tr_b16 v[70:71], v33 offset:16768
  ds_read_b128 v[72:75], v36 offset:192
  s_waitcnt lgkmcnt(6)
  v_mfma_f32_16x16x32_bf16 v[16:19], v[44:47], v[40:43], v[16:19]
  v_mfma_f32_16x16x32_bf16 v[20:23], v[48:51], v[40:43], v[20:23]
  v_mfma_f32_16x16x32_bf16 v[24:27], v[52:55], v[40:43], v[24:27]
  s_waitcnt lgkmcnt(0)
  v_mfma_f32_16x16x32_bf16 v[16:19], v[64:67], v[60:63], v[16:19]
  v_mfma_f32_16x16x32_bf16 v[20:23], v[68:71], v[60:63], v[20:23]
  v_mfma_f32_16x16x32_bf16 v[24:27], v[72:75], v[60:63], v[24:27]
ve_27:
  s_cmp_ge_u32 s3, 4
  s_cbranch_scc1 vb_28
  s_waitcnt vmcnt(0)
  s_barrier
  v_add_u32 v33, 20480, v12
  v_add_u32 v80, 65536, v8
  v_add_u32 v81, 65536, v9
  v_add_u32 v82, 65536, v10
  v_add_u32 v83, 65536, v11
  ds_read_b128 v[40:43], v80 offset:0
  ds_read_b64_tr_b16 v[44:45], v33 offset:0
  ds_read_b64_tr_b16 v[46:47], v33 offset:1280
  ds_read_b64_tr_b16 v[48:49], v33 offset:32
  ds_read_b64_tr_b16 v[50:51], v33 offset:1312
  ds_read_b64_tr_b16 v[52:53], v33 offset:64
  ds_read_b64_tr_b16 v[54:55], v33 offset:1344
  ds_read_b128 v[60:63], v81 offset:0
  ds_read_b64_tr_b16 v[64:65], v33 offset:5120
  ds_read_b64_tr_b16 v[66:67], v33 offset:6400
  ds_read_b64_tr_b16 v[68:69], v33 offset:5152
  ds_read_b64_tr_b16 v[70:71], v33 offset:6432
  ds_read_b64_tr_b16 v[72:73], v33 offset:5184
  ds_read_b64_tr_b16 v[74:75], v33 offset:6464
  s_cmp_lg_u32 s3, 3
  s_cbranch_scc1 ow_30
  v_lshlrev_b32 v100, 6, v1
  s_mov_b32 s92, 18022400
  buffer_load_dword v101, v100, s[8:11], s92 offen sc1
  s_add_u32 s92, s92, 4096
  buffer_load_dword v102, v100, s[8:11], s92 offen sc1
  s_add_u32 s92, s92, 4096
  buffer_load_dword v103, v100, s[8:11], s92 offen sc1
  s_add_u32 s92, s92, 4096
  buffer_load_dword v104, v100, s[8:11], s92 offen sc1
ow_30:
  s_waitcnt lgkmcnt(7)
  v_mfma_f32_16x16x32_bf16 v[16:19], v[44:47], v[40:43], v[16:19]
  v_mfma_f32_16x16x32_bf16 v[20:23], v[48:51], v[40:43], v[20:23]
  v_mfma_f32_16x16x32_bf16 v[24:27], v[52:55], v[40:43], v[24:27]
  ds_read_b128 v[40:43], v82 offset:0
  ds_read_b64_tr_b16 v[44:45], v33 offset:10240
  ds_read_b64_tr_b16 v[46:47], v33 offset:11520
  ds_read_b64_tr_b16 v[48:49], v33 offset:10272
  ds_read_b64_tr_b16 v[50:51], v33 offset:11552
  ds_read_b64_tr_b16 v[52:53], v33 offset:10304
  ds_read_b64_tr_b16 v[54:55], v33 offset:11584
  s_waitcnt lgkmcnt(7)
  v_mfma_f32_16x16x32_bf16 v[16:19], v[64:67], v[60:63], v[16:19]
  v_mfma_f32_16x16x32_bf16 v[20:23], v[68:71], v[60:63], v[20:23]
  v_mfma_f32_16x16x32_bf16 v[24:27], v[72:75], v[60:63], v[24:27]
  ds_read_b128 v[60:63], v83 offset:0
  ds_read_b64_tr_b16 v[64:65], v33 offset:15360
  ds_read_b64_tr_b16 v[66:67], v33 offset:16640
  ds_read_b64_tr_b16 v[68:69], v33 offset:15392
  ds_read_b64_tr_b16 v[70:71], v33 offset:16672
  ds_read_b64_tr_b16 v[72:73], v33 offset:15424
  ds_read_b64_tr_b16 v[74:75], v33 offset:16704
  s_waitcnt lgkmcnt(7)
  v_mfma_f32_16x16x32_bf16 v[16:19], v[44:47], v[40:43], v[16:19]
  v_mfma_f32_16x16x32_bf16 v[20:23], v[48:51], v[40:43], v[20:23]
  v_mfma_f32_16x16x32_bf16 v[24:27], v[52:55], v[40:43], v[24:27]
  s_waitcnt lgkmcnt(0)
  v_mfma_f32_16x16x32_bf16 v[16:19], v[64:67], v[60:63], v[16:19]
  v_mfma_f32_16x16x32_bf16 v[20:23], v[68:71], v[60:63], v[20:23]
  v_mfma_f32_16x16x32_bf16 v[24:27], v[72:75], v[60:63], v[24:27]
  s_branch ve_29
vb_28:
  s_waitcnt vmcnt(0)
  s_barrier
  v_add_u32 v33, 20480, v12
  v_add_u32 v80, 65536, v8
  v_add_u32 v81, 65536, v9
  v_add_u32 v82, 65536, v10
  v_add_u32 v83, 65536, v11
  s_mul_i32 s56, s54, 256
  v_add_u32 v36, s56, v115
  ds_read_b128 v[40:43], v80 offset:0
  ds_read_b64_tr_b16 v[44:45], v33 offset:96
  ds_read_b64_tr_b16 v[46:47], v33 offset:1376
  ds_read_b64_tr_b16 v[48:49], v33 offset:128
  ds_read_b64_tr_b16 v[50:51], v33 offset:1408
  ds_read_b128 v[52:55], v36 offset:0
  ds_read_b128 v[60:63], v81 offset:0
  ds_read_b64_tr_b16 v[64:65], v33 offset:5216
  ds_read_b64_tr_b16 v[66:67], v33 offset:6496
  ds_read_b64_tr_b16 v[68:69], v33 offset:5248
  ds_read_b64_tr_b16 v[70:71], v33 offset:6528
  ds_read_b128 v[72:75], v36 offset:64
  s_cmp_lg_u32 s3, 7
  s_cbranch_scc1 ow_31
  v_lshlrev_b32 v100, 6, v1
  s_mov_b32 s92, 18038784
  buffer_load_dword v101, v100, s[8:11], s92 offen sc1
  s_add_u32 s92, s92, 4096
  buffer_load_dword v102, v100, s[8:11], s92 offen sc1
  s_add_u32 s92, s92, 4096
  buffer_load_dword v103, v100, s[8:11], s92 offen sc1
  s_add_u32 s92, s92, 4096
  buffer_load_dword v104, v100, s[8:11], s92 offen sc1
ow_31:
  s_waitcnt lgkmcnt(6)
  v_mfma_f32_16x16x32_bf16 v[16:19], v[44:47], v[40:43], v[16:19]
  v_mfma_f32_16x16x32_bf16 v[20:23], v[48:51], v[40:43], v[20:23]
  v_mfma_f32_16x16x32_bf16 v[24:27], v[52:55], v[40:43], v[24:27]
  ds_read_b128 v[40:43], v82 offset:0
  ds_read_b64_tr_b16 v[44:45], v33 offset:10336
  ds_read_b64_tr_b16 v[46:47], v33 offset:11616
  ds_read_b64_tr_b16 v[48:49], v33 offset:10368
  ds_read_b64_tr_b16 v[50:51], v33 offset:11648
  ds_read_b128 v[52:55], v36 offset:128
  s_waitcnt lgkmcnt(6)
  v_mfma_f32_16x16x32_bf16 v[16:19], v[64:67], v[60:63], v[16:19]
  v_mfma_f32_16x16x32_bf16 v[20:23], v[68:71], v[60:63], v[20:23]
  v_mfma_f32_16x16x32_bf16 v[24:27], v[72:75], v[60:63], v[24:27]
  ds_read_b128 v[60:63], v83 offset:0
  ds_read_b64_tr_b16 v[64:65], v33 offset:15456
  ds_read_b64_tr_b16 v[66:67], v33 offset:16736
  ds_read_b64_tr_b16 v[68:69], v33 offset:15488
  ds_read_b64_tr_b16 v[70:71], v33 offset:16768
  ds_read_b128 v[72:75], v36 offset:192
  s_waitcnt lgkmcnt(6)
  v_mfma_f32_16x16x32_bf16 v[16:19], v[44:47], v[40:43], v[16:19]
  v_mfma_f32_16x16x32_bf16 v[20:23], v[48:51], v[40:43], v[20:23]
  v_mfma_f32_16x16x32_bf16 v[24:27], v[52:55], v[40:43], v[24:27]
  s_waitcnt lgkmcnt(0)
  v_mfma_f32_16x16x32_bf16 v[16:19], v[64:67], v[60:63], v[16:19]
  v_mfma_f32_16x16x32_bf16 v[20:23], v[68:71], v[60:63], v[20:23]
  v_mfma_f32_16x16x32_bf16 v[24:27], v[72:75], v[60:63], v[24:27]
ve_29:
  s_nop 7
  s_mul_i32 s56, s3, 1536
  s_add_u32 s56, s56, 149800
  v_mul_u32_u24 v80, 48, v4
  v_add_u32 v80, s56, v80
  v_mov_b32 v82, 0
  v_mov_b32 v83, 0
  ds_write_b64 v80, v[82:83]
  s_lshr_b32 s56, s51, 1
  s_mul_i32 s56, s56, 6144
  s_and_b32 s57, s51, 1
  s_mul_i32 s57, s57, 768
  s_add_u32 s56, s56, s57
  s_add_u32 s56, s56, 149760
  v_mul_u32_u24 v80, 48, v2
  v_add_u32 v80, s56, v80
  v_mov_b32 v81, 0x3ea52b5c
  s_cmp_ge_u32 s3, 4
  s_cbranch_scc1 qe_32
  v_mul_f32 v16, v16, v81
  v_mul_f32 v17, v17, v81
  v_mul_f32 v18, v18, v81
  v_mul_f32 v19, v19, v81
  v_cvt_pk_bf16_f32 v16, v16, v17
  v_cvt_pk_bf16_f32 v17, v18, v19
  v_add_u32 v82, 0, v3
  v_mul_u32_u24 v83, 52, v82
  v_lshrrev_b32 v83, 8, v83
  v_mul_u32_u24 v84, 5, v83
  v_sub_u32 v84, v82, v84
  v_mul_u32_u24 v83, 1536, v83
  v_lshl_add_u32 v83, v84, 3, v83
  v_add_u32 v83, v83, v80
  ds_write_b64 v83, v[16:17]
  v_mul_f32 v20, v20, v81
  v_mul_f32 v21, v21, v81
  v_mul_f32 v22, v22, v81
  v_mul_f32 v23, v23, v81
  v_cvt_pk_bf16_f32 v20, v20, v21
  v_cvt_pk_bf16_f32 v21, v22, v23
  v_add_u32 v82, 4, v3
  v_mul_u32_u24 v83, 52, v82
  v_lshrrev_b32 v83, 8, v83
  v_mul_u32_u24 v84, 5, v83
  v_sub_u32 v84, v82, v84
  v_mul_u32_u24 v83, 1536, v83
  v_lshl_add_u32 v83, v84, 3, v83
  v_add_u32 v83, v83, v80
  ds_write_b64 v83, v[20:21]
  v_mul_f32 v24, v24, v81
  v_mul_f32 v25, v25, v81
  v_mul_f32 v26, v26, v81
  v_mul_f32 v27, v27, v81
  v_cvt_pk_bf16_f32 v24, v24, v25
  v_cvt_pk_bf16_f32 v25, v26, v27
  v_add_u32 v82, 8, v3
  v_mul_u32_u24 v83, 52, v82
  v_lshrrev_b32 v83, 8, v83
  v_mul_u32_u24 v84, 5, v83
  v_sub_u32 v84, v82, v84
  v_mul_u32_u24 v83, 1536, v83
  v_lshl_add_u32 v83, v84, 3, v83
  v_add_u32 v83, v83, v80
  ds_write_b64 v83, v[24:25]
  s_branch qe_33
qe_32:
  v_mul_f32 v16, v16, v81
  v_mul_f32 v17, v17, v81
  v_mul_f32 v18, v18, v81
  v_mul_f32 v19, v19, v81
  v_cvt_pk_bf16_f32 v16, v16, v17
  v_cvt_pk_bf16_f32 v17, v18, v19
  v_add_u32 v82, 12, v3
  v_mul_u32_u24 v83, 52, v82
  v_lshrrev_b32 v83, 8, v83
  v_mul_u32_u24 v84, 5, v83
  v_sub_u32 v84, v82, v84
  v_mul_u32_u24 v83, 1536, v83
  v_lshl_add_u32 v83, v84, 3, v83
  v_add_u32 v83, v83, v80
  ds_write_b64 v83, v[16:17]
  v_mul_f32 v20, v20, v81
  v_mul_f32 v21, v21, v81
  v_mul_f32 v22, v22, v81
  v_mul_f32 v23, v23, v81
  v_cvt_pk_bf16_f32 v20, v20, v21
  v_cvt_pk_bf16_f32 v21, v22, v23
  v_add_u32 v82, 16, v3
  v_mul_u32_u24 v83, 52, v82
  v_lshrrev_b32 v83, 8, v83
  v_mul_u32_u24 v84, 5, v83
  v_sub_u32 v84, v82, v84
  v_mul_u32_u24 v83, 1536, v83
  v_lshl_add_u32 v83, v84, 3, v83
  v_add_u32 v83, v83, v80
  ds_write_b64 v83, v[20:21]
  s_lshl_b32 s56, s51, 6
  s_add_u32 s56, s56, 162048
  v_lshlrev_b32 v82, 2, v2
  v_add_u32 v82, s56, v82
  ds_write_b32 v82, v24
qe_33:
  s_cmp_lg_u32 s3, 3
  s_cbranch_scc1 ow_34
  s_waitcnt vmcnt(0)
  v_cmp_ne_u32 vcc, s50, v101
  s_mov_b64 s[94:95], vcc
  v_cmp_ne_u32 vcc, s50, v102
  s_or_b64 s[94:95], s[94:95], vcc
  v_cmp_ne_u32 vcc, s50, v103
  s_or_b64 s[94:95], s[94:95], vcc
  v_cmp_ne_u32 vcc, s50, v104
  s_or_b64 s[94:95], s[94:95], vcc
  s_cmp_eq_u64 s[94:95], 0
  s_cbranch_scc1 pchk_35
  v_lshlrev_b32 v100, 6, v1
  s_mov_b32 s91, 18022400
  s_mov_b32 s90, 0
poll_36:
  s_mov_b32 s92, s91
  buffer_load_dword v101, v100, s[8:11], s92 offen sc1
  s_add_u32 s92, s92, 4096
  buffer_load_dword v102, v100, s[8:11], s92 offen sc1
  s_add_u32 s92, s92, 4096
  buffer_load_dword v103, v100, s[8:11], s92 offen sc1
  s_add_u32 s92, s92, 4096
  buffer_load_dword v104, v100, s[8:11], s92 offen sc1
  s_waitcnt vmcnt(0)
  v_cmp_ne_u32 vcc, s50, v101
  s_mov_b64 s[94:95], vcc
  v_cmp_ne_u32 vcc, s50, v102
  s_or_b64 s[94:95], s[94:95], vcc
  v_cmp_ne_u32 vcc, s50, v103
  s_or_b64 s[94:95], s[94:95], vcc
  v_cmp_ne_u32 vcc, s50, v104
  s_or_b64 s[94:95], s[94:95], vcc
  s_cmp_eq_u64 s[94:95], 0
  s_cbranch_scc1 polld_37
  s_add_u32 s90, s90, 1
  s_cmp_ge_u32 s90, 0x40000
  s_cbranch_scc1 polld_37
  s_sleep 1
  s_branch poll_36
polld_37:
pchk_35:
ow_34:
  s_cmp_lg_u32 s3, 7
  s_cbranch_scc1 ow_38
  s_waitcnt vmcnt(0)
  v_cmp_ne_u32 vcc, s50, v101
  s_mov_b64 s[94:95], vcc
  v_cmp_ne_u32 vcc, s50, v102
  s_or_b64 s[94:95], s[94:95], vcc
  v_cmp_ne_u32 vcc, s50, v103
  s_or_b64 s[94:95], s[94:95], vcc
  v_cmp_ne_u32 vcc, s50, v104
  s_or_b64 s[94:95], s[94:95], vcc
  s_cmp_eq_u64 s[94:95], 0
  s_cbranch_scc1 pchk_39
  v_lshlrev_b32 v100, 6, v1
  s_mov_b32 s91, 18038784
  s_mov_b32 s90, 0
poll_40:
  s_mov_b32 s92, s91
  buffer_load_dword v101, v100, s[8:11], s92 offen sc1
  s_add_u32 s92, s92, 4096
  buffer_load_dword v102, v100, s[8:11], s92 offen sc1
  s_add_u32 s92, s92, 4096
  buffer_load_dword v103, v100, s[8:11], s92 offen sc1
  s_add_u32 s92, s92, 4096
  buffer_load_dword v104, v100, s[8:11], s92 offen sc1
  s_waitcnt vmcnt(0)
  v_cmp_ne_u32 vcc, s50, v101
  s_mov_b64 s[94:95], vcc
  v_cmp_ne_u32 vcc, s50, v102
  s_or_b64 s[94:95], s[94:95], vcc
  v_cmp_ne_u32 vcc, s50, v103
  s_or_b64 s[94:95], s[94:95], vcc
  v_cmp_ne_u32 vcc, s50, v104
  s_or_b64 s[94:95], s[94:95], vcc
  s_cmp_eq_u64 s[94:95], 0
  s_cbranch_scc1 polld_41
  s_add_u32 s90, s90, 1
  s_cmp_ge_u32 s90, 0x40000
  s_cbranch_scc1 polld_41
  s_sleep 1
  s_branch poll_40
polld_41:
pchk_39:
ow_38:
  s_waitcnt lgkmcnt(0)
  s_barrier
  s_lshl_b32 s56, s51, 6
  s_add_u32 s56, s56, 162048
  v_lshlrev_b32 v82, 2, v2
  v_add_u32 v82, s56, v82
  ds_read_b32 v6, v82
  s_and_b32 s56, s3, 1
  s_mul_i32 s56, s56, 6144
  s_add_u32 s56, s56, 149760
  v_mul_u32_u24 v80, 48, v4
  v_add_u32 v80, s56, v80
  v_lshl_add_u32 v81, v5, 4, v80
  v_lshl_add_u32 v82, v5, 3, v80
  ds_read_b128 a[64:67], v81 offset:0
  ds_read_b64 a[80:81], v82 offset:32
  ds_read_b128 a[68:71], v81 offset:1536
  ds_read_b64 a[82:83], v82 offset:1568
  ds_read_b128 a[72:75], v81 offset:3072
  ds_read_b64 a[84:85], v82 offset:3104
  ds_read_b128 a[76:79], v81 offset:4608
  ds_read_b64 a[86:87], v82 offset:4640
  s_waitcnt lgkmcnt(0)
  s_cmp_lt_u32 s3, 4
  s_cbranch_scc1 qr_42
  v_mov_b32 v80, 162868
  v_mov_b32 v81, 1
  s_mov_b64 s[56:57], exec
  s_mov_b64 exec, 1
  ds_add_u32 v80, v81
  s_mov_b64 exec, s[56:57]
qr_42:
  s_cmp_ge_u32 s3, 4
  s_cbranch_scc1 bg_43
  s_setprio 3
  s_mul_i32 s85, s49, 102400
  s_add_u32 s85, s85, 15728640
  v_add_u32 v12, 81920, v14
  s_mul_i32 s76, s4, 20480
  s_add_u32 s76, s76, s85
  s_add_u32 s76, s76, s53
  s_add_u32 m0, s53, 81920
  s_nop 0
  buffer_load_dwordx4 v14, s[8:11], s76 offen sc1 lds
  s_mul_i32 s76, s4, 20480
  s_add_u32 s76, s76, s85
  s_add_u32 s76, s76, 4096
  s_add_u32 s76, s76, s53
  s_add_u32 m0, s53, 86016
  s_nop 0
  buffer_load_dwordx4 v14, s[8:11], s76 offen sc1 lds
  s_mul_i32 s76, s4, 20480
  s_add_u32 s76, s76, s85
  s_add_u32 s76, s76, 8192
  s_add_u32 s76, s76, s53
  s_add_u32 m0, s53, 90112
  s_nop 0
  buffer_load_dwordx4 v14, s[8:11], s76 offen sc1 lds
  s_mul_i32 s76, s4, 20480
  s_add_u32 s76, s76, s85
  s_add_u32 s76, s76, 12288
  s_add_u32 s76, s76, s53
  s_add_u32 m0, s53, 94208
  s_nop 0
  buffer_load_dwordx4 v14, s[8:11], s76 offen sc1 lds
  s_mul_i32 s76, s4, 20480
  s_add_u32 s76, s76, s85
  s_add_u32 s76, s76, 16384
  s_add_u32 s76, s76, s53
  s_add_u32 m0, s53, 98304
  s_nop 0
  buffer_load_dwordx4 v14, s[8:11], s76 offen sc1 lds
  s_mul_i32 s76, s5, 20480
  s_add_u32 s76, s76, s85
  s_add_u32 s76, s76, s53
  s_add_u32 m0, s53, 102400
  s_nop 0
  buffer_load_dwordx4 v14, s[8:11], s76 offen sc1 lds
  s_mul_i32 s76, s5, 20480
  s_add_u32 s76, s76, s85
  s_add_u32 s76, s76, 4096
  s_add_u32 s76, s76, s53
  s_add_u32 m0, s53, 106496
  s_nop 0
  buffer_load_dwordx4 v14, s[8:11], s76 offen sc1 lds
  s_mul_i32 s76, s5, 20480
  s_add_u32 s76, s76, s85
  s_add_u32 s76, s76, 8192
  s_add_u32 s76, s76, s53
  s_add_u32 m0, s53, 110592
  s_nop 0
  buffer_load_dwordx4 v14, s[8:11], s76 offen sc1 lds
  s_mul_i32 s76, s5, 20480
  s_add_u32 s76, s76, s85
  s_add_u32 s76, s76, 12288
  s_add_u32 s76, s76, s53
  s_add_u32 m0, s53, 114688
  s_nop 0
  buffer_load_dwordx4 v14, s[8:11], s76 offen sc1 lds
  s_mul_i32 s76, s5, 20480
  s_add_u32 s76, s76, s85
  s_add_u32 s76, s76, 16384
  s_add_u32 s76, s76, s53
  s_add_u32 m0, s53, 118784
  s_nop 0
  buffer_load_dwordx4 v14, s[8:11], s76 offen sc1 lds
  v_mov_b32 v92, 162816
  v_mov_b32 v94, 1
  s_waitcnt vmcnt(5)
  s_waitcnt lgkmcnt(0)
  s_mov_b64 s[94:95], exec
  s_mov_b64 exec, 1
  ds_add_rtn_u32 v93, v92, v94
  s_mov_b32 s88, 0
  s_waitcnt lgkmcnt(0)
  v_readfirstlane_b32 s89, v93
  s_cmp_ge_u32 s89, 3
  s_cbranch_scc1 sb_45
sb_44:
  ds_read_b32 v93, v92
  s_waitcnt lgkmcnt(0)
  v_readfirstlane_b32 s89, v93
  s_cmp_ge_u32 s89, 4
  s_cbranch_scc1 sb_45
  s_add_u32 s88, s88, 1
  s_cmp_lt_u32 s88, 0x100000
  s_cbranch_scc1 sb_44
sb_45:
  s_mov_b64 exec, s[94:95]
  v_add_u32 v88, 0, v12
  ds_read_b128 v[36:39], v8 offset:0
  ds_read_b128 v[40:43], v88 offset:0
  ds_read_b128 v[44:47], v88 offset:1024
  ds_read_b128 v[48:51], v88 offset:2048
  ds_read_b128 v[52:55], v88 offset:3072
  ds_read_b128 v[56:59], v88 offset:4096
  ds_read_b128 v[60:63], v9 offset:0
  ds_read_b128 v[64:67], v88 offset:5120
  ds_read_b128 v[68:71], v88 offset:6144
  ds_read_b128 v[72:75], v88 offset:7168
  ds_read_b128 v[76:79], v88 offset:8192
  ds_read_b128 v[80:83], v88 offset:9216
  s_mul_i32 s76, s6, 20480
  s_add_u32 s76, s76, s85
  s_add_u32 s76, s76, s53
  s_add_u32 m0, s53, 122880
  s_nop 0
  buffer_load_dwordx4 v14, s[8:11], s76 offen sc1 lds
  s_waitcnt lgkmcnt(6)
  v_mfma_f32_16x16x32_bf16 v[16:19], v[36:39], v[40:43], 0
  v_mfma_f32_16x16x32_bf16 v[20:23], v[36:39], v[44:47], 0
  v_mfma_f32_16x16x32_bf16 v[24:27], v[36:39], v[48:51], 0
  v_mfma_f32_16x16x32_bf16 v[28:31], v[36:39], v[52:55], 0
  v_mfma_f32_16x16x32_bf16 v[32:35], v[36:39], v[56:59], 0
  ds_read_b128 v[36:39], v10 offset:0
  ds_read_b128 v[40:43], v88 offset:10240
  ds_read_b128 v[44:47], v88 offset:11264
  ds_read_b128 v[48:51], v88 offset:12288
  ds_read_b128 v[52:55], v88 offset:13312
  ds_read_b128 v[56:59], v88 offset:14336
  s_mul_i32 s76, s6, 20480
  s_add_u32 s76, s76, s85
  s_add_u32 s76, s76, 4096
  s_add_u32 s76, s76, s53
  s_add_u32 m0, s53, 126976
  s_nop 0
  buffer_load_dwordx4 v14, s[8:11], s76 offen sc1 lds
  s_mul_i32 s76, s6, 20480
  s_add_u32 s76, s76, s85
  s_add_u32 s76, s76, 8192
  s_add_u32 s76, s76, s53
  s_add_u32 m0, s53, 131072
  s_nop 0
  buffer_load_dwordx4 v14, s[8:11], s76 offen sc1 lds
  s_waitcnt lgkmcnt(6)
  v_mfma_f32_16x16x32_bf16 v[16:19], v[60:63], v[64:67], v[16:19]
  v_mfma_f32_16x16x32_bf16 v[20:23], v[60:63], v[68:71], v[20:23]
  v_mfma_f32_16x16x32_bf16 v[24:27], v[60:63], v[72:75], v[24:27]
  v_mfma_f32_16x16x32_bf16 v[28:31], v[60:63], v[76:79], v[28:31]
  v_mfma_f32_16x16x32_bf16 v[32:35], v[60:63], v[80:83], v[32:35]
  ds_read_b128 v[60:63], v11 offset:0
  ds_read_b128 v[64:67], v88 offset:15360
  ds_read_b128 v[68:71], v88 offset:16384
  ds_read_b128 v[72:75], v88 offset:17408
  ds_read_b128 v[76:79], v88 offset:18432
  ds_read_b128 v[80:83], v88 offset:19456
  s_mul_i32 s76, s6, 20480
  s_add_u32 s76, s76, s85
  s_add_u32 s76, s76, 12288
  s_add_u32 s76, s76, s53
  s_add_u32 m0, s53, 135168
  s_nop 0
  buffer_load_dwordx4 v14, s[8:11], s76 offen sc1 lds
  s_mul_i32 s76, s6, 20480
  s_add_u32 s76, s76, s85
  s_add_u32 s76, s76, 16384
  s_add_u32 s76, s76, s53
  s_add_u32 m0, s53, 139264
  s_nop 0
  buffer_load_dwordx4 v14, s[8:11], s76 offen sc1 lds
  s_waitcnt lgkmcnt(6)
  v_mfma_f32_16x16x32_bf16 v[16:19], v[36:39], v[40:43], v[16:19]
  v_mfma_f32_16x16x32_bf16 v[20:23], v[36:39], v[44:47], v[20:23]
  v_mfma_f32_16x16x32_bf16 v[24:27], v[36:39], v[48:51], v[24:27]
  v_mfma_f32_16x16x32_bf16 v[28:31], v[36:39], v[52:55], v[28:31]
  v_mfma_f32_16x16x32_bf16 v[32:35], v[36:39], v[56:59], v[32:35]
  v_lshlrev_b32 v108, 7, v1
  v_min_u32 v109, 4992, v108
  s_mul_i32 s76, s7, 20480
  s_add_u32 s76, s76, s85
  s_mul_i32 s77, s3, 5120
  s_add_u32 s76, s76, s77
  buffer_load_dword v110, v109, s[8:11], s76 offen sc1
  s_mul_i32 s76, s54, 20480
  s_add_u32 s76, s76, s85
  s_mul_i32 s77, s3, 5120
  s_add_u32 s76, s76, s77
  buffer_load_dword v110, v109, s[8:11], s76 offen sc1
  s_waitcnt lgkmcnt(0)
  v_mfma_f32_16x16x32_bf16 v[16:19], v[60:63], v[64:67], v[16:19]
  v_mfma_f32_16x16x32_bf16 v[20:23], v[60:63], v[68:71], v[20:23]
  v_mfma_f32_16x16x32_bf16 v[24:27], v[60:63], v[72:75], v[24:27]
  v_mfma_f32_16x16x32_bf16 v[28:31], v[60:63], v[76:79], v[28:31]
  v_mfma_f32_16x16x32_bf16 v[32:35], v[60:63], v[80:83], v[32:35]
  s_waitcnt vmcnt(7)
  s_waitcnt lgkmcnt(0)
  s_mov_b64 s[94:95], exec
  s_mov_b64 exec, 1
  ds_add_rtn_u32 v93, v92, v94
  s_mov_b32 s88, 0
  s_waitcnt lgkmcnt(0)
  v_readfirstlane_b32 s89, v93
  s_cmp_ge_u32 s89, 7
  s_cbranch_scc1 sb_47
sb_46:
  ds_read_b32 v93, v92
  s_waitcnt lgkmcnt(0)
  v_readfirstlane_b32 s89, v93
  s_cmp_ge_u32 s89, 8
  s_cbranch_scc1 sb_47
  s_add_u32 s88, s88, 1
  s_cmp_lt_u32 s88, 0x100000
  s_cbranch_scc1 sb_46
sb_47:
  s_mov_b64 exec, s[94:95]
  v_add_u32 v88, 20480, v12
  ds_read_b128 v[36:39], v8 offset:16384
  ds_read_b128 v[40:43], v88 offset:0
  ds_read_b128 v[44:47], v88 offset:1024
  ds_read_b128 v[48:51], v88 offset:2048
  ds_read_b128 v[52:55], v88 offset:3072
  ds_read_b128 v[56:59], v88 offset:4096
  ds_read_b128 v[60:63], v9 offset:16384
  ds_read_b128 v[64:67], v88 offset:5120
  ds_read_b128 v[68:71], v88 offset:6144
  ds_read_b128 v[72:75], v88 offset:7168
  ds_read_b128 v[76:79], v88 offset:8192
  ds_read_b128 v[80:83], v88 offset:9216
  s_mul_i32 s76, s7, 20480
  s_add_u32 s76, s76, s85
  s_add_u32 s76, s76, s53
  s_add_u32 m0, s53, 81920
  s_nop 0
  buffer_load_dwordx4 v14, s[8:11], s76 offen sc1 lds
  s_waitcnt lgkmcnt(6)
  v_mfma_f32_16x16x32_bf16 v[16:19], v[36:39], v[40:43], v[16:19]
  v_mfma_f32_16x16x32_bf16 v[20:23], v[36:39], v[44:47], v[20:23]
  v_mfma_f32_16x16x32_bf16 v[24:27], v[36:39], v[48:51], v[24:27]
  v_mfma_f32_16x16x32_bf16 v[28:31], v[36:39], v[52:55], v[28:31]
  v_mfma_f32_16x16x32_bf16 v[32:35], v[36:39], v[56:59], v[32:35]
  ds_read_b128 v[36:39], v10 offset:16384
  ds_read_b128 v[40:43], v88 offset:10240
  ds_read_b128 v[44:47], v88 offset:11264
  ds_read_b128 v[48:51], v88 offset:12288
  ds_read_b128 v[52:55], v88 offset:13312
  ds_read_b128 v[56:59], v88 offset:14336
  s_mul_i32 s76, s7, 20480
  s_add_u32 s76, s76, s85
  s_add_u32 s76, s76, 4096
  s_add_u32 s76, s76, s53
  s_add_u32 m0, s53, 86016
  s_nop 0
  buffer_load_dwordx4 v14, s[8:11], s76 offen sc1 lds
  s_mul_i32 s76, s7, 20480
  s_add_u32 s76, s76, s85
  s_add_u32 s76, s76, 8192
  s_add_u32 s76, s76, s53
  s_add_u32 m0, s53, 90112
  s_nop 0
  buffer_load_dwordx4 v14, s[8:11], s76 offen sc1 lds
  s_waitcnt lgkmcnt(6)
  v_mfma_f32_16x16x32_bf16 v[16:19], v[60:63], v[64:67], v[16:19]
  v_mfma_f32_16x16x32_bf16 v[20:23], v[60:63], v[68:71], v[20:23]
  v_mfma_f32_16x16x32_bf16 v[24:27], v[60:63], v[72:75], v[24:27]
  v_mfma_f32_16x16x32_bf16 v[28:31], v[60:63], v[76:79], v[28:31]
  v_mfma_f32_16x16x32_bf16 v[32:35], v[60:63], v[80:83], v[32:35]
  ds_read_b128 v[60:63], v11 offset:16384
  ds_read_b128 v[64:67], v88 offset:15360
  ds_read_b128 v[68:71], v88 offset:16384
  ds_read_b128 v[72:75], v88 offset:17408
  ds_read_b128 v[76:79], v88 offset:18432
  ds_read_b128 v[80:83], v88 offset:19456
  s_mul_i32 s76, s7, 20480
  s_add_u32 s76, s76, s85
  s_add_u32 s76, s76, 12288
  s_add_u32 s76, s76, s53
  s_add_u32 m0, s53, 94208
  s_nop 0
  buffer_load_dwordx4 v14, s[8:11], s76 offen sc1 lds
  s_mul_i32 s76, s7, 20480
  s_add_u32 s76, s76, s85
  s_add_u32 s76, s76, 16384
  s_add_u32 s76, s76, s53
  s_add_u32 m0, s53, 98304
  s_nop 0
  buffer_load_dwordx4 v14, s[8:11], s76 offen sc1 lds
  s_waitcnt lgkmcnt(6)
  v_mfma_f32_16x16x32_bf16 v[16:19], v[36:39], v[40:43], v[16:19]
  v_mfma_f32_16x16x32_bf16 v[20:23], v[36:39], v[44:47], v[20:23]
  v_mfma_f32_16x16x32_bf16 v[24:27], v[36:39], v[48:51], v[24:27]
  v_mfma_f32_16x16x32_bf16 v[28:31], v[36:39], v[52:55], v[28:31]
  v_mfma_f32_16x16x32_bf16 v[32:35], v[36:39], v[56:59], v[32:35]
  v_mov_b32 v96, 162868
  s_mov_b32 s88, 0
sp_48:
  ds_read_b32 v97, v96
  s_waitcnt lgkmcnt(0)
  v_readfirstlane_b32 s89, v97
  s_cmp_ge_u32 s89, 4
  s_cbranch_scc1 sp_49
  s_add_u32 s88, s88, 1
  s_cmp_ge_u32 s88, 0x100000
  s_cbranch_scc1 sp_49
  s_sleep 1
  s_branch sp_48
sp_49:
  s_lshr_b32 s56, s2, 2
  s_lshr_b32 s57, s56, 5
  s_bfe_u32 s58, s56, 0x20003
  s_bfe_u32 s59, s56, 0x10002
  s_and_b32 s60, s56, 3
  s_lshl_b32 s61, s58, 4
  s_lshl_b32 s62, s59, 3
  s_add_u32 s61, s61, s62
  s_add_u32 s61, s61, s57
  s_lshl_b32 s61, s61, 5
  s_lshl_b32 s62, s60, 3
  s_add_u32 s61, s61, s62
  s_mul_i32 s61, s61, 642
  s_and_b32 s62, s2, 3
  s_mul_i32 s62, s62, 162
  s_add_u32 s61, s61, s62
  s_mul_i32 s63, s3, 3
  s_cmp_ge_u32 s63, 6
  s_cselect_b32 s64, 6, 0
  s_sub_u32 s65, s63, s64
  s_lshl_b32 s66, s65, 6
  v_add_u32 v96, s66, v1
  v_mul_u32_u24 v97, 745, v96
  v_lshrrev_b32 v97, 13, v97
  v_mul_u32_u24 v98, 11, v97
  v_sub_u32 v98, v96, v98
  v_lshrrev_b32 v99, 2, v97
  v_and_b32 v97, 3, v97
  v_lshl_add_u32 v99, v97, 6, v99
  v_mul_u32_u24 v99, 642, v99
  v_lshl_add_u32 v99, v98, 4, v99
  v_mov_b32 v100, 0x7fffffff
  v_cmp_gt_u32 vcc, 352, v96
  s_lshl_b32 s66, s65, 10
  s_mul_i32 s67, s64, 1024
  v_cndmask_b32 v99, v100, v99, vcc
  s_add_u32 s66, s66, s67
  s_add_u32 m0, s66, 149760
  s_cmp_ge_u32 s63, 6
  s_cbranch_scc1 wr_50
  buffer_load_dwordx4 v99, s[36:39], s61 offen lds
  s_branch wr_51
wr_50:
  buffer_load_dwordx4 v99, s[40:43], s61 offen lds
wr_51:
  s_add_u32 s63, s63, 1
  s_cmp_ge_u32 s63, 6
  s_cselect_b32 s64, 6, 0
  s_sub_u32 s65, s63, s64
  s_lshl_b32 s66, s65, 6
  v_add_u32 v96, s66, v1
  v_mul_u32_u24 v97, 745, v96
  v_lshrrev_b32 v97, 13, v97
  v_mul_u32_u24 v98, 11, v97
  v_sub_u32 v98, v96, v98
  v_lshrrev_b32 v99, 2, v97
  v_and_b32 v97, 3, v97
  v_lshl_add_u32 v99, v97, 6, v99
  v_mul_u32_u24 v99, 642, v99
  v_lshl_add_u32 v99, v98, 4, v99
  v_mov_b32 v100, 0x7fffffff
  v_cmp_gt_u32 vcc, 352, v96
  s_lshl_b32 s66, s65, 10
  s_mul_i32 s67, s64, 1024
  v_cndmask_b32 v99, v100, v99, vcc
  s_add_u32 s66, s66, s67
  s_add_u32 m0, s66, 149760
  s_cmp_ge_u32 s63, 6
  s_cbranch_scc1 wr_52
  buffer_load_dwordx4 v99, s[36:39], s61 offen lds
  s_branch wr_53
wr_52:
  buffer_load_dwordx4 v99, s[40:43], s61 offen lds
wr_53:
  s_add_u32 s63, s63, 1
  s_cmp_ge_u32 s63, 6
  s_cselect_b32 s64, 6, 0
  s_sub_u32 s65, s63, s64
  s_lshl_b32 s66, s65, 6
  v_add_u32 v96, s66, v1
  v_mul_u32_u24 v97, 745, v96
  v_lshrrev_b32 v97, 13, v97
  v_mul_u32_u24 v98, 11, v97
  v_sub_u32 v98, v96, v98
  v_lshrrev_b32 v99, 2, v97
  v_and_b32 v97, 3, v97
  v_lshl_add_u32 v99, v97, 6, v99
  v_mul_u32_u24 v99, 642, v99
  v_lshl_add_u32 v99, v98, 4, v99
  v_mov_b32 v100, 0x7fffffff
  v_cmp_gt_u32 vcc, 352, v96
  s_lshl_b32 s66, s65, 10
  s_mul_i32 s67, s64, 1024
  v_cndmask_b32 v99, v100, v99, vcc
  s_add_u32 s66, s66, s67
  s_add_u32 m0, s66, 149760
  s_cmp_ge_u32 s63, 6
  s_cbranch_scc1 wr_54
  buffer_load_dwordx4 v99, s[36:39], s61 offen lds
  s_branch wr_55
wr_54:
  buffer_load_dwordx4 v99, s[40:43], s61 offen lds
wr_55:
  s_waitcnt lgkmcnt(0)
  v_mfma_f32_16x16x32_bf16 v[16:19], v[60:63], v[64:67], v[16:19]
  v_mfma_f32_16x16x32_bf16 v[20:23], v[60:63], v[68:71], v[20:23]
  v_mfma_f32_16x16x32_bf16 v[24:27], v[60:63], v[72:75], v[24:27]
  v_mfma_f32_16x16x32_bf16 v[28:31], v[60:63], v[76:79], v[28:31]
  v_mfma_f32_16x16x32_bf16 v[32:35], v[60:63], v[80:83], v[32:35]
  s_waitcnt vmcnt(10)
  s_waitcnt lgkmcnt(0)
  s_mov_b64 s[94:95], exec
  s_mov_b64 exec, 1
  ds_add_rtn_u32 v93, v92, v94
  s_mov_b32 s88, 0
  s_waitcnt lgkmcnt(0)
  v_readfirstlane_b32 s89, v93
  s_cmp_ge_u32 s89, 11
  s_cbranch_scc1 sb_57
sb_56:
  ds_read_b32 v93, v92
  s_waitcnt lgkmcnt(0)
  v_readfirstlane_b32 s89, v93
  s_cmp_ge_u32 s89, 12
  s_cbranch_scc1 sb_57
  s_add_u32 s88, s88, 1
  s_cmp_lt_u32 s88, 0x100000
  s_cbranch_scc1 sb_56
sb_57:
  s_mov_b64 exec, s[94:95]
  v_add_u32 v88, 40960, v12
  ds_read_b128 v[36:39], v8 offset:32768
  ds_read_b128 v[40:43], v88 offset:0
  ds_read_b128 v[44:47], v88 offset:1024
  ds_read_b128 v[48:51], v88 offset:2048
  ds_read_b128 v[52:55], v88 offset:3072
  ds_read_b128 v[56:59], v88 offset:4096
  ds_read_b128 v[60:63], v9 offset:32768
  ds_read_b128 v[64:67], v88 offset:5120
  ds_read_b128 v[68:71], v88 offset:6144
  ds_read_b128 v[72:75], v88 offset:7168
  ds_read_b128 v[76:79], v88 offset:8192
  ds_read_b128 v[80:83], v88 offset:9216
  s_mul_i32 s76, s54, 20480
  s_add_u32 s76, s76, s85
  s_add_u32 s76, s76, s53
  s_add_u32 m0, s53, 102400
  s_nop 0
  buffer_load_dwordx4 v14, s[8:11], s76 offen sc1 lds
  s_waitcnt lgkmcnt(6)
  v_mfma_f32_16x16x32_bf16 v[16:19], v[36:39], v[40:43], v[16:19]
  v_mfma_f32_16x16x32_bf16 v[20:23], v[36:39], v[44:47], v[20:23]
  v_mfma_f32_16x16x32_bf16 v[24:27], v[36:39], v[48:51], v[24:27]
  v_mfma_f32_16x16x32_bf16 v[28:31], v[36:39], v[52:55], v[28:31]
  v_mfma_f32_16x16x32_bf16 v[32:35], v[36:39], v[56:59], v[32:35]
  ds_read_b128 v[36:39], v10 offset:32768
  ds_read_b128 v[40:43], v88 offset:10240
  ds_read_b128 v[44:47], v88 offset:11264
  ds_read_b128 v[48:51], v88 offset:12288
  ds_read_b128 v[52:55], v88 offset:13312
  ds_read_b128 v[56:59], v88 offset:14336
  s_mul_i32 s76, s54, 20480
  s_add_u32 s76, s76, s85
  s_add_u32 s76, s76, 4096
  s_add_u32 s76, s76, s53
  s_add_u32 m0, s53, 106496
  s_nop 0
  buffer_load_dwordx4 v14, s[8:11], s76 offen sc1 lds
  s_mul_i32 s76, s54, 20480
  s_add_u32 s76, s76, s85
  s_add_u32 s76, s76, 8192
  s_add_u32 s76, s76, s53
  s_add_u32 m0, s53, 110592
  s_nop 0
  buffer_load_dwordx4 v14, s[8:11], s76 offen sc1 lds
  s_waitcnt lgkmcnt(6)
  v_mfma_f32_16x16x32_bf16 v[16:19], v[60:63], v[64:67], v[16:19]
  v_mfma_f32_16x16x32_bf16 v[20:23], v[60:63], v[68:71], v[20:23]
  v_mfma_f32_16x16x32_bf16 v[24:27], v[60:63], v[72:75], v[24:27]
  v_mfma_f32_16x16x32_bf16 v[28:31], v[60:63], v[76:79], v[28:31]
  v_mfma_f32_16x16x32_bf16 v[32:35], v[60:63], v[80:83], v[32:35]
  ds_read_b128 v[60:63], v11 offset:32768
  ds_read_b128 v[64:67], v88 offset:15360
  ds_read_b128 v[68:71], v88 offset:16384
  ds_read_b128 v[72:75], v88 offset:17408
  ds_read_b128 v[76:79], v88 offset:18432
  ds_read_b128 v[80:83], v88 offset:19456
  s_mul_i32 s76, s54, 20480
  s_add_u32 s76, s76, s85
  s_add_u32 s76, s76, 12288
  s_add_u32 s76, s76, s53
  s_add_u32 m0, s53, 114688
  s_nop 0
  buffer_load_dwordx4 v14, s[8:11], s76 offen sc1 lds
  s_mul_i32 s76, s54, 20480
  s_add_u32 s76, s76, s85
  s_add_u32 s76, s76, 16384
  s_add_u32 s76, s76, s53
  s_add_u32 m0, s53, 118784
  s_nop 0
  buffer_load_dwordx4 v14, s[8:11], s76 offen sc1 lds
  s_waitcnt lgkmcnt(6)
  v_mfma_f32_16x16x32_bf16 v[16:19], v[36:39], v[40:43], v[16:19]
  v_mfma_f32_16x16x32_bf16 v[20:23], v[36:39], v[44:47], v[20:23]
  v_mfma_f32_16x16x32_bf16 v[24:27], v[36:39], v[48:51], v[24:27]
  v_mfma_f32_16x16x32_bf16 v[28:31], v[36:39], v[52:55], v[28:31]
  v_mfma_f32_16x16x32_bf16 v[32:35], v[36:39], v[56:59], v[32:35]
  s_cmp_lg_u32 s3, 2
  s_cbranch_scc1 blk_58
  s_cmp_ge_u32 s2, 160
  s_cbranch_scc1 blk_58
  s_add_u32 s72, s2, 160
  s_mov_b32 s73, 143360
  s_cmp_ge_u32 s72, 160
  s_cselect_b32 s75, 160, 0
  s_sub_u32 s76, s72, s75
  s_mul_i32 s77, s76, 205
  s_lshr_b32 s77, s77, 12
  s_mul_i32 s78, s77, 20
  s_sub_u32 s78, s76, s78
  s_mul_i32 s74, s76, 5120
  s_cmp_ge_u32 s72, 160
  s_mov_b32 s75, 262144
  s_cselect_b32 s75, 1310720, s75
  s_add_u32 s74, s74, s75
  s_mul_i32 s78, s78, 40960
  s_mul_i32 s77, s77, 160
  s_add_u32 s78, s78, s77
  v_and_b32 v96, 31, v1
  v_lshrrev_b32 v96, 1, v96
  v_and_b32 v97, 3, v96
  v_and_b32 v98, 4, v96
  v_lshl_add_u32 v97, v98, 1, v97
  v_and_b32 v98, 8, v96
  v_lshrrev_b32 v98, 1, v98
  v_add_u32 v97, v97, v98
  v_mul_u32_u24 v97, 1280, v97
  v_and_b32 v98, 1, v1
  v_lshl_add_u32 v97, v98, 4, v97
  v_mul_u32_u24 v99, 32, v5
  v_add_u32 v99, v99, v97
  s_add_u32 s79, s78, 0
  s_add_u32 m0, s73, 0
  s_cmp_ge_u32 s72, 160
  s_cbranch_scc1 blk_61
  buffer_load_dwordx4 v99, s[16:19], s79 offen lds
  s_branch blk_62
blk_61:
  buffer_load_dwordx4 v99, s[28:31], s79 offen lds
blk_62:
  v_mul_u32_u24 v99, 32, v5
  v_add_u32 v99, v99, v97
  s_add_u32 s79, s78, 64
  s_add_u32 m0, s73, 1024
  s_cmp_ge_u32 s72, 160
  s_cbranch_scc1 blk_63
  buffer_load_dwordx4 v99, s[16:19], s79 offen lds
  s_branch blk_64
blk_63:
  buffer_load_dwordx4 v99, s[28:31], s79 offen lds
blk_64:
  v_mul_u32_u24 v99, 20352, v5
  v_add_u32 v99, v99, v97
  s_add_u32 s79, s78, 128
  s_add_u32 m0, s73, 2048
  s_cmp_ge_u32 s72, 160
  s_cbranch_scc1 blk_65
  buffer_load_dwordx4 v99, s[16:19], s79 offen lds
  s_branch blk_66
blk_65:
  buffer_load_dwordx4 v99, s[28:31], s79 offen lds
blk_66:
  v_mul_u32_u24 v99, 32, v5
  v_add_u32 v99, v99, v97
  s_add_u32 s79, s78, 20512
  s_add_u32 m0, s73, 3072
  s_cmp_ge_u32 s72, 160
  s_cbranch_scc1 blk_67
  buffer_load_dwordx4 v99, s[16:19], s79 offen lds
  s_branch blk_68
blk_67:
  buffer_load_dwordx4 v99, s[28:31], s79 offen lds
blk_68:
  v_mul_u32_u24 v99, 32, v5
  v_add_u32 v99, v99, v97
  s_add_u32 s79, s78, 20576
  s_add_u32 m0, s73, 4096
  s_cmp_ge_u32 s72, 160
  s_cbranch_scc1 blk_69
  buffer_load_dwordx4 v99, s[16:19], s79 offen lds
  s_branch blk_70
blk_69:
  buffer_load_dwordx4 v99, s[28:31], s79 offen lds
blk_70:
blk_58:
  s_waitcnt lgkmcnt(0)
  v_mfma_f32_16x16x32_bf16 v[16:19], v[60:63], v[64:67], v[16:19]
  v_mfma_f32_16x16x32_bf16 v[20:23], v[60:63], v[68:71], v[20:23]
  v_mfma_f32_16x16x32_bf16 v[24:27], v[60:63], v[72:75], v[24:27]
  v_mfma_f32_16x16x32_bf16 v[28:31], v[60:63], v[76:79], v[28:31]
  v_mfma_f32_16x16x32_bf16 v[32:35], v[60:63], v[80:83], v[32:35]
  s_waitcnt vmcnt(8)
  s_waitcnt lgkmcnt(0)
  s_mov_b64 s[94:95], exec
  s_mov_b64 exec, 1
  ds_add_rtn_u32 v93, v92, v94
  s_mov_b32 s88, 0
  s_waitcnt lgkmcnt(0)
  v_readfirstlane_b32 s89, v93
  s_cmp_ge_u32 s89, 15
  s_cbranch_scc1 sb_72
sb_71:
  ds_read_b32 v93, v92
  s_waitcnt lgkmcnt(0)
  v_readfirstlane_b32 s89, v93
  s_cmp_ge_u32 s89, 16
  s_cbranch_scc1 sb_72
  s_add_u32 s88, s88, 1
  s_cmp_lt_u32 s88, 0x100000
  s_cbranch_scc1 sb_71
sb_72:
  s_mov_b64 exec, s[94:95]
  v_add_u32 v88, 0, v12
  ds_read_b128 v[36:39], v8 offset:49152
  ds_read_b128 v[40:43], v88 offset:0
  ds_read_b128 v[44:47], v88 offset:1024
  ds_read_b128 v[48:51], v88 offset:2048
  ds_read_b128 v[52:55], v88 offset:3072
  ds_read_b128 v[56:59], v88 offset:4096
  ds_read_b128 v[60:63], v9 offset:49152
  ds_read_b128 v[64:67], v88 offset:5120
  ds_read_b128 v[68:71], v88 offset:6144
  ds_read_b128 v[72:75], v88 offset:7168
  ds_read_b128 v[76:79], v88 offset:8192
  ds_read_b128 v[80:83], v88 offset:9216
  s_waitcnt lgkmcnt(6)
  v_mfma_f32_16x16x32_bf16 v[16:19], v[36:39], v[40:43], v[16:19]
  v_mfma_f32_16x16x32_bf16 v[20:23], v[36:39], v[44:47], v[20:23]
  v_mfma_f32_16x16x32_bf16 v[24:27], v[36:39], v[48:51], v[24:27]
  v_mfma_f32_16x16x32_bf16 v[28:31], v[36:39], v[52:55], v[28:31]
  v_mfma_f32_16x16x32_bf16 v[32:35], v[36:39], v[56:59], v[32:35]
  ds_read_b128 v[36:39], v10 offset:49152
  ds_read_b128 v[40:43], v88 offset:10240
  ds_read_b128 v[44:47], v88 offset:11264
  ds_read_b128 v[48:51], v88 offset:12288
  ds_read_b128 v[52:55], v88 offset:13312
  ds_read_b128 v[56:59], v88 offset:14336
  s_waitcnt lgkmcnt(6)
  v_mfma_f32_16x16x32_bf16 v[16:19], v[60:63], v[64:67], v[16:19]
  v_mfma_f32_16x16x32_bf16 v[20:23], v[60:63], v[68:71], v[20:23]
  v_mfma_f32_16x16x32_bf16 v[24:27], v[60:63], v[72:75], v[24:27]
  v_mfma_f32_16x16x32_bf16 v[28:31], v[60:63], v[76:79], v[28:31]
  v_mfma_f32_16x16x32_bf16 v[32:35], v[60:63], v[80:83], v[32:35]
  ds_read_b128 v[60:63], v11 offset:49152
  ds_read_b128 v[64:67], v88 offset:15360
  ds_read_b128 v[68:71], v88 offset:16384
  ds_read_b128 v[72:75], v88 offset:17408
  ds_read_b128 v[76:79], v88 offset:18432
  ds_read_b128 v[80:83], v88 offset:19456
  s_waitcnt lgkmcnt(6)
  v_mfma_f32_16x16x32_bf16 v[16:19], v[36:39], v[40:43], v[16:19]
  v_mfma_f32_16x16x32_bf16 v[20:23], v[36:39], v[44:47], v[20:23]
  v_mfma_f32_16x16x32_bf16 v[24:27], v[36:39], v[48:51], v[24:27]
  v_mfma_f32_16x16x32_bf16 v[28:31], v[36:39], v[52:55], v[28:31]
  v_mfma_f32_16x16x32_bf16 v[32:35], v[36:39], v[56:59], v[32:35]
  s_waitcnt lgkmcnt(0)
  v_mfma_f32_16x16x32_bf16 v[16:19], v[60:63], v[64:67], v[16:19]
  v_mfma_f32_16x16x32_bf16 v[20:23], v[60:63], v[68:71], v[20:23]
  v_mfma_f32_16x16x32_bf16 v[24:27], v[60:63], v[72:75], v[24:27]
  v_mfma_f32_16x16x32_bf16 v[28:31], v[60:63], v[76:79], v[28:31]
  v_mfma_f32_16x16x32_bf16 v[32:35], v[60:63], v[80:83], v[32:35]
  s_waitcnt vmcnt(0)
  s_waitcnt lgkmcnt(0)
  s_mov_b64 s[94:95], exec
  s_mov_b64 exec, 1
  ds_add_rtn_u32 v93, v92, v94
  s_mov_b32 s88, 0
  s_waitcnt lgkmcnt(0)
  v_readfirstlane_b32 s89, v93
  s_cmp_ge_u32 s89, 19
  s_cbranch_scc1 sb_74
sb_73:
  ds_read_b32 v93, v92
  s_waitcnt lgkmcnt(0)
  v_readfirstlane_b32 s89, v93
  s_cmp_ge_u32 s89, 20
  s_cbranch_scc1 sb_74
  s_add_u32 s88, s88, 1
  s_cmp_lt_u32 s88, 0x100000
  s_cbranch_scc1 sb_73
sb_74:
  s_mov_b64 exec, s[94:95]
  v_add_u32 v88, 20480, v12
  v_add_u32 v84, 65536, v8
  v_add_u32 v85, 65536, v9
  v_add_u32 v86, 65536, v10
  v_add_u32 v87, 65536, v11
  ds_read_b128 v[36:39], v84 offset:0
  ds_read_b128 v[40:43], v88 offset:0
  ds_read_b128 v[44:47], v88 offset:1024
  ds_read_b128 v[48:51], v88 offset:2048
  ds_read_b128 v[52:55], v88 offset:3072
  ds_read_b128 v[56:59], v88 offset:4096
  ds_read_b128 v[60:63], v85 offset:0
  ds_read_b128 v[64:67], v88 offset:5120
  ds_read_b128 v[68:71], v88 offset:6144
  ds_read_b128 v[72:75], v88 offset:7168
  ds_read_b128 v[76:79], v88 offset:8192
  ds_read_b128 v[80:83], v88 offset:9216
  s_mov_b32 s78, s3
  s_lshr_b32 s56, s2, 2
  s_lshr_b32 s57, s56, 5
  s_bfe_u32 s58, s56, 0x20003
  s_bfe_u32 s59, s56, 0x10002
  s_and_b32 s60, s56, 3
  v_lshrrev_b32 v96, 2, v2
  v_lshl_add_u32 v96, v3, 2, v96
  v_mul_u32_u24 v96, 176, v96
  v_and_b32 v97, 3, v2
  v_lshl_add_u32 v96, v97, 3, v96
  s_mov_b32 s61, s78
  s_lshl_b32 s62, s61, 5
  s_add_u32 s62, s62, 149760
  v_add_u32 v96, s62, v96
  ds_read_b64_tr_b16 v[100:101], v96 offset:0
  ds_read_b64_tr_b16 v[102:103], v96 offset:6144
  ds_read_b64_tr_b16 v[104:105], v96 offset:2816
  ds_read_b64_tr_b16 v[106:107], v96 offset:8960
  s_lshl_b32 s63, s57, 2
  s_add_u32 s63, s63, s58
  s_lshl_b32 s63, s63, 10
  s_lshl_b32 s64, s59, 9
  s_add_u32 s63, s63, s64
  s_lshl_b32 s64, s60, 7
  s_add_u32 s63, s63, s64
  s_add_u32 s63, s63, 12648448
  s_and_b32 s64, s2, 3
  s_mul_i32 s64, s64, 81
  s_lshl_b32 s65, s61, 4
  v_add_u32 v97, s65, v2
  v_add_u32 v98, s64, v97
  v_lshlrev_b32 v99, 13, v98
  v_lshl_add_u32 v99, v3, 4, v99
  v_mov_b32 v108, 0x7fffffff
  v_cmp_gt_u32 vcc, 321, v98
  s_nop 1
  v_cndmask_b32 v99, v108, v99, vcc
  v_cmp_gt_u32 vcc, 81, v97
  s_nop 1
  v_cndmask_b32 v99, v108, v99, vcc
  s_mov_b32 s64, 0x05040100
  s_mov_b32 s65, 0x07060302
  s_waitcnt lgkmcnt(0)
  v_perm_b32 v112, v102, v100, s64
  v_perm_b32 v113, v102, v100, s65
  v_perm_b32 v114, v103, v101, s64
  v_perm_b32 v115, v103, v101, s65
  buffer_store_dwordx4 v[112:115], v99, s[8:11], s63 offen offset:0 sc1
  v_perm_b32 v116, v106, v104, s64
  v_perm_b32 v117, v106, v104, s65
  v_perm_b32 v118, v107, v105, s64
  v_perm_b32 v119, v107, v105, s65
  buffer_store_dwordx4 v[116:119], v99, s[8:11], s63 offen offset:64 sc1
  s_cmp_ge_u32 s3, 2
  s_cbranch_scc1 wt2_75
  s_add_u32 s78, s3, 4
  s_lshr_b32 s56, s2, 2
  s_lshr_b32 s57, s56, 5
  s_bfe_u32 s58, s56, 0x20003
  s_bfe_u32 s59, s56, 0x10002
  s_and_b32 s60, s56, 3
  v_lshrrev_b32 v96, 2, v2
  v_lshl_add_u32 v96, v3, 2, v96
  v_mul_u32_u24 v96, 176, v96
  v_and_b32 v97, 3, v2
  v_lshl_add_u32 v96, v97, 3, v96
  s_mov_b32 s61, s78
  s_lshl_b32 s62, s61, 5
  s_add_u32 s62, s62, 149760
  v_add_u32 v96, s62, v96
  ds_read_b64_tr_b16 v[100:101], v96 offset:0
  ds_read_b64_tr_b16 v[102:103], v96 offset:6144
  ds_read_b64_tr_b16 v[104:105], v96 offset:2816
  ds_read_b64_tr_b16 v[106:107], v96 offset:8960
  s_lshl_b32 s63, s57, 2
  s_add_u32 s63, s63, s58
  s_lshl_b32 s63, s63, 10
  s_lshl_b32 s64, s59, 9
  s_add_u32 s63, s63, s64
  s_lshl_b32 s64, s60, 7
  s_add_u32 s63, s63, s64
  s_add_u32 s63, s63, 12648448
  s_and_b32 s64, s2, 3
  s_mul_i32 s64, s64, 81
  s_lshl_b32 s65, s61, 4
  v_add_u32 v97, s65, v2
  v_add_u32 v98, s64, v97
  v_lshlrev_b32 v99, 13, v98
  v_lshl_add_u32 v99, v3, 4, v99
  v_mov_b32 v108, 0x7fffffff
  v_cmp_gt_u32 vcc, 321, v98
  s_nop 1
  v_cndmask_b32 v99, v108, v99, vcc
  v_cmp_gt_u32 vcc, 81, v97
  s_nop 1
  v_cndmask_b32 v99, v108, v99, vcc
  s_mov_b32 s64, 0x05040100
  s_mov_b32 s65, 0x07060302
  s_waitcnt lgkmcnt(0)
  v_perm_b32 v112, v102, v100, s64
  v_perm_b32 v113, v102, v100, s65
  v_perm_b32 v114, v103, v101, s64
  v_perm_b32 v115, v103, v101, s65
  buffer_store_dwordx4 v[112:115], v99, s[8:11], s63 offen offset:0 sc1
  v_perm_b32 v116, v106, v104, s64
  v_perm_b32 v117, v106, v104, s65
  v_perm_b32 v118, v107, v105, s64
  v_perm_b32 v119, v107, v105, s65
  buffer_store_dwordx4 v[116:119], v99, s[8:11], s63 offen offset:64 sc1
wt2_75:
  s_cmp_lg_u32 s3, 2
  s_cbranch_scc1 blk_76
  s_cmp_ge_u32 s2, 160
  s_cbranch_scc1 blk_76
  v_lshrrev_b32 v97, 1, v3
  v_mul_u32_u24 v96, 2560, v97
  v_and_b32 v97, 1, v3
  v_lshl_add_u32 v96, v97, 7, v96
  v_lshrrev_b32 v97, 2, v2
  v_lshl_add_u32 v96, v97, 5, v96
  v_and_b32 v97, 3, v2
  v_lshl_add_u32 v96, v97, 3, v96
  v_add_u32 v96, 0, v96
  v_add_u32 v96, s73, v96
  ds_read_b64_tr_b16 v[100:101], v96 offset:0
  ds_read_b64_tr_b16 v[102:103], v96 offset:256
  ds_read_b64_tr_b16 v[104:105], v96 offset:512
  ds_read_b64_tr_b16 v[106:107], v96 offset:768
  ds_read_b64_tr_b16 v[108:109], v96 offset:1024
  ds_read_b64_tr_b16 v[110:111], v96 offset:1280
  ds_read_b64_tr_b16 v[112:113], v96 offset:1536
  ds_read_b64_tr_b16 v[114:115], v96 offset:1792
  ds_read_b64_tr_b16 v[116:117], v96 offset:2048
  ds_read_b64_tr_b16 v[118:119], v96 offset:2304
  s_waitcnt lgkmcnt(0)
  buffer_store_dwordx4 v[100:103], v14, s[8:11], s74 offen offset:0 sc1
  buffer_store_dwordx4 v[104:107], v14, s[8:11], s74 offen offset:1024 sc1
  buffer_store_dwordx4 v[108:111], v14, s[8:11], s74 offen offset:2048 sc1
  buffer_store_dwordx4 v[112:115], v14, s[8:11], s74 offen offset:3072 sc1
  s_add_u32 s74, s74, 4096
  buffer_store_dwordx4 v[116:119], v14, s[8:11], s74 offen sc1
blk_76:
  s_waitcnt lgkmcnt(6)
  v_mfma_f32_16x16x32_bf16 v[16:19], v[36:39], v[40:43], v[16:19]
  v_mfma_f32_16x16x32_bf16 v[20:23], v[36:39], v[44:47], v[20:23]
  v_mfma_f32_16x16x32_bf16 v[24:27], v[36:39], v[48:51], v[24:27]
  v_mfma_f32_16x16x32_bf16 v[28:31], v[36:39], v[52:55], v[28:31]
  v_mfma_f32_16x16x32_bf16 v[32:35], v[36:39], v[56:59], v[32:35]
  ds_read_b128 v[36:39], v86 offset:0
  ds_read_b128 v[40:43], v88 offset:10240
  ds_read_b128 v[44:47], v88 offset:11264
  ds_read_b128 v[48:51], v88 offset:12288
  ds_read_b128 v[52:55], v88 offset:13312
  ds_read_b128 v[56:59], v88 offset:14336
  s_waitcnt lgkmcnt(6)
  v_mfma_f32_16x16x32_bf16 v[16:19], v[60:63], v[64:67], v[16:19]
  v_mfma_f32_16x16x32_bf16 v[20:23], v[60:63], v[68:71], v[20:23]
  v_mfma_f32_16x16x32_bf16 v[24:27], v[60:63], v[72:75], v[24:27]
  v_mfma_f32_16x16x32_bf16 v[28:31], v[60:63], v[76:79], v[28:31]
  v_mfma_f32_16x16x32_bf16 v[32:35], v[60:63], v[80:83], v[32:35]
  ds_read_b128 v[60:63], v87 offset:0
  ds_read_b128 v[64:67], v88 offset:15360
  ds_read_b128 v[68:71], v88 offset:16384
  ds_read_b128 v[72:75], v88 offset:17408
  ds_read_b128 v[76:79], v88 offset:18432
  ds_read_b128 v[80:83], v88 offset:19456
  s_waitcnt lgkmcnt(6)
  v_mfma_f32_16x16x32_bf16 v[16:19], v[36:39], v[40:43], v[16:19]
  v_mfma_f32_16x16x32_bf16 v[20:23], v[36:39], v[44:47], v[20:23]
  v_mfma_f32_16x16x32_bf16 v[24:27], v[36:39], v[48:51], v[24:27]
  v_mfma_f32_16x16x32_bf16 v[28:31], v[36:39], v[52:55], v[28:31]
  v_mfma_f32_16x16x32_bf16 v[32:35], v[36:39], v[56:59], v[32:35]
  s_waitcnt lgkmcnt(0)
  v_mfma_f32_16x16x32_bf16 v[16:19], v[60:63], v[64:67], v[16:19]
  v_mfma_f32_16x16x32_bf16 v[20:23], v[60:63], v[68:71], v[20:23]
  v_mfma_f32_16x16x32_bf16 v[24:27], v[60:63], v[72:75], v[24:27]
  v_mfma_f32_16x16x32_bf16 v[28:31], v[60:63], v[76:79], v[28:31]
  v_mfma_f32_16x16x32_bf16 v[32:35], v[60:63], v[80:83], v[32:35]
  s_nop 7
  s_waitcnt lgkmcnt(0)
  s_mov_b64 s[94:95], exec
  s_mov_b64 exec, 1
  ds_add_rtn_u32 v93, v92, v94
  s_mov_b32 s88, 0
  s_waitcnt lgkmcnt(0)
  v_readfirstlane_b32 s89, v93
  s_cmp_ge_u32 s89, 23
  s_cbranch_scc1 sb_78
sb_77:
  ds_read_b32 v93, v92
  s_waitcnt lgkmcnt(0)
  v_readfirstlane_b32 s89, v93
  s_cmp_ge_u32 s89, 24
  s_cbranch_scc1 sb_78
  s_add_u32 s88, s88, 1
  s_cmp_lt_u32 s88, 0x100000
  s_cbranch_scc1 sb_77
sb_78:
  s_mov_b64 exec, s[94:95]
  v_mul_u32_u24 v96, 144, v2
  v_lshl_add_u32 v96, v3, 3, v96
  s_lshl_b32 s56, s51, 5
  s_add_u32 s56, s56, 0
  v_add_u32 v96, s56, v96
  v_cvt_pk_bf16_f32 v16, v16, v17
  v_cvt_pk_bf16_f32 v17, v18, v19
  ds_write_b64 v96, v[16:17] offset:0
  v_cvt_pk_bf16_f32 v20, v20, v21
  v_cvt_pk_bf16_f32 v21, v22, v23
  ds_write_b64 v96, v[20:21] offset:2304
  v_cvt_pk_bf16_f32 v24, v24, v25
  v_cvt_pk_bf16_f32 v25, v26, v27
  ds_write_b64 v96, v[24:25] offset:4608
  v_cvt_pk_bf16_f32 v28, v28, v29
  v_cvt_pk_bf16_f32 v29, v30, v31
  ds_write_b64 v96, v[28:29] offset:6912
  v_cvt_pk_bf16_f32 v32, v32, v33
  v_cvt_pk_bf16_f32 v33, v34, v35
  ds_write_b64 v96, v[32:33] offset:9216
  s_waitcnt lgkmcnt(0)
  s_mov_b64 s[94:95], exec
  s_mov_b64 exec, 1
  ds_add_rtn_u32 v93, v92, v94
  s_mov_b32 s88, 0
  s_waitcnt lgkmcnt(0)
  v_readfirstlane_b32 s89, v93
  s_cmp_ge_u32 s89, 27
  s_cbranch_scc1 sb_80
sb_79:
  ds_read_b32 v93, v92
  s_waitcnt lgkmcnt(0)
  v_readfirstlane_b32 s89, v93
  s_cmp_ge_u32 s89, 28
  s_cbranch_scc1 sb_80
  s_add_u32 s88, s88, 1
  s_cmp_lt_u32 s88, 0x100000
  s_cbranch_scc1 sb_79
sb_80:
  s_mov_b64 exec, s[94:95]
  v_lshrrev_b32 v96, 3, v0
  v_and_b32 v97, 7, v0
  v_mul_u32_u24 v98, 144, v96
  v_lshl_add_u32 v98, v97, 4, v98
  ds_read_b128 v[40:43], v98 offset:0
  ds_read_b128 v[44:47], v98 offset:4608
  ds_read_b128 v[48:51], v98 offset:9216
  v_lshlrev_b32 v99, 12, v96
  v_lshl_add_u32 v99, v97, 4, v99
  s_mul_i32 s56, s49, 327680
  s_lshl_b32 s57, s48, 7
  s_add_u32 s56, s56, s57
  s_add_u32 s56, s56, 6356992
  s_waitcnt lgkmcnt(0)
  buffer_store_dwordx4 v[40:43], v99, s[8:11], s56 offen sc1
  s_add_u32 s56, s56, 131072
x1s_81:
  buffer_store_dwordx4 v[44:47], v99, s[8:11], s56 offen sc1
  s_add_u32 s56, s56, 131072
x1s_82:
  s_cmp_ge_u32 s3, 2
  s_cbranch_scc1 x1s_83
  buffer_store_dwordx4 v[48:51], v99, s[8:11], s56 offen sc1
  s_add_u32 s56, s56, 131072
x1s_83:
  s_waitcnt lgkmcnt(0)
  s_mov_b64 s[94:95], exec
  s_mov_b64 exec, 1
  ds_add_rtn_u32 v93, v92, v94
  s_mov_b32 s88, 0
  s_waitcnt lgkmcnt(0)
  v_readfirstlane_b32 s89, v93
  s_cmp_ge_u32 s89, 31
  s_cbranch_scc1 sb_85
sb_84:
  ds_read_b32 v93, v92
  s_waitcnt lgkmcnt(0)
  v_readfirstlane_b32 s89, v93
  s_cmp_ge_u32 s89, 32
  s_cbranch_scc1 sb_85
  s_add_u32 s88, s88, 1
  s_cmp_lt_u32 s88, 0x100000
  s_cbranch_scc1 sb_84
sb_85:
  s_mov_b64 exec, s[94:95]
  s_add_u32 s76, s53, 17825792
  s_add_u32 m0, s53, 0
  s_nop 0
  buffer_load_dwordx4 v14, s[8:11], s76 offen sc1 lds
stb_86:
  s_add_u32 s76, s53, 17829888
  s_add_u32 m0, s53, 4096
  s_nop 0
  buffer_load_dwordx4 v14, s[8:11], s76 offen sc1 lds
stb_87:
  s_add_u32 s76, s53, 17833984
  s_add_u32 m0, s53, 8192
  s_nop 0
  buffer_load_dwordx4 v14, s[8:11], s76 offen sc1 lds
stb_88:
  s_add_u32 s76, s53, 17838080
  s_add_u32 m0, s53, 12288
  s_nop 0
  buffer_load_dwordx4 v14, s[8:11], s76 offen sc1 lds
stb_89:
  s_add_u32 s76, s53, 17842176
  s_add_u32 m0, s53, 16384
  s_nop 0
  buffer_load_dwordx4 v14, s[8:11], s76 offen sc1 lds
stb_90:
  s_add_u32 s76, s53, 17846272
  s_add_u32 m0, s53, 20480
  s_nop 0
  buffer_load_dwordx4 v14, s[8:11], s76 offen sc1 lds
stb_91:
  s_add_u32 s76, s53, 17850368
  s_add_u32 m0, s53, 24576
  s_nop 0
  buffer_load_dwordx4 v14, s[8:11], s76 offen sc1 lds
stb_92:
  s_add_u32 s76, s53, 17854464
  s_add_u32 m0, s53, 28672
  s_nop 0
  buffer_load_dwordx4 v14, s[8:11], s76 offen sc1 lds
stb_93:
  s_add_u32 s76, s53, 17858560
  s_add_u32 m0, s53, 32768
  s_nop 0
  buffer_load_dwordx4 v14, s[8:11], s76 offen sc1 lds
stb_94:
  s_add_u32 s76, s53, 17862656
  s_add_u32 m0, s53, 36864
  s_nop 0
  buffer_load_dwordx4 v14, s[8:11], s76 offen sc1 lds
stb_95:
  s_add_u32 s76, s53, 17866752
  s_add_u32 m0, s53, 40960
  s_nop 0
  buffer_load_dwordx4 v14, s[8:11], s76 offen sc1 lds
stb_96:
  s_add_u32 s76, s53, 17870848
  s_add_u32 m0, s53, 45056
  s_nop 0
  buffer_load_dwordx4 v14, s[8:11], s76 offen sc1 lds
stb_97:
  s_cmp_ge_u32 s3, 2
  s_cbranch_scc1 stb_98
  s_add_u32 s76, s53, 17874944
  s_add_u32 m0, s53, 49152
  s_nop 0
  buffer_load_dwordx4 v14, s[8:11], s76 offen sc1 lds
stb_98:
  s_waitcnt vmcnt(0)
  v_mov_b32 v92, 162820
  v_mov_b32 v93, 1
  s_mov_b64 s[94:95], exec
  s_mov_b64 exec, 1
  ds_add_rtn_u32 v93, v92, v93
  s_waitcnt lgkmcnt(0)
  v_readfirstlane_b32 s89, v93
  s_mov_b64 exec, s[94:95]
  s_cmp_lg_u32 s89, 3
  s_cbranch_scc1 cnt_99
  s_lshl_b32 s86, s2, 6
  s_add_u32 s86, s86, 18055168
  v_mov_b32 v15, s50
  s_mov_b64 s[88:89], exec
  s_mov_b64 exec, 1
  buffer_store_dword v15, off, s[8:11], s86 sc1
  s_mov_b64 exec, s[88:89]
cnt_99:
bg_43:
  s_mov_b32 s83, 0
  s_and_b32 s70, s3, 1
  s_lshr_b32 s71, s3, 1
  v_lshlrev_b32 v60, 4, v1
  v_lshlrev_b32 v61, 3, v1
  v_min_u32 v62, 20, v4
  v_mad_u32_u24 v62, v5, 21, v62
  v_lshlrev_b32 v62, 4, v62
  s_lshl_b32 s56, s3, 2
  s_xor_b32 s57, s56, 16
  s_add_u32 s56, s56, 162832
  s_add_u32 s57, s57, 162832
  v_mov_b32 v8, s56
  v_mov_b32 v9, s57
  v_mov_b32 v63, 0
  s_lshl_b32 s69, s3, 8
  s_add_u32 s69, s69, s2
  s_cmp_le_u32 s2, 64
  s_cselect_b32 s56, 1, 0
  s_cmp_eq_u32 s70, 0
  s_cselect_b32 s56, 1, s56
  s_cmp_eq_u32 s56, 0
  s_cbranch_scc1 split_100
  s_cmp_eq_u32 s71, 0
  s_cselect_b32 s57, 0, s57
  s_cselect_b32 s64, 8, s64
  s_cmp_eq_u32 s71, 1
  s_cselect_b32 s57, 8, s57
  s_cselect_b32 s64, 20, s64
  s_cmp_eq_u32 s71, 2
  s_cselect_b32 s57, 28, s57
  s_cselect_b32 s64, 20, s64
  s_cmp_eq_u32 s71, 3
  s_cselect_b32 s57, 48, s57
  s_cselect_b32 s64, 16, s64
  s_branch split_101
split_100:
  s_cmp_eq_u32 s71, 0
  s_cselect_b32 s57, 0, s57
  s_cselect_b32 s64, 16, s64
  s_cmp_eq_u32 s71, 1
  s_cselect_b32 s57, 16, s57
  s_cselect_b32 s64, 16, s64
  s_cmp_eq_u32 s71, 2
  s_cselect_b32 s57, 32, s57
  s_cselect_b32 s64, 16, s64
  s_cmp_eq_u32 s71, 3
  s_cselect_b32 s57, 48, s57
  s_cselect_b32 s64, 16, s64
split_101:
  s_mul_i32 s74, s57, 2880
  s_add_u32 s74, s74, 0
  s_mul_i32 s73, s64, 2880
  s_add_u32 s73, s73, s74
  s_lshr_b32 s65, s2, 3
  s_cmp_ge_u32 s65, s64
  s_cselect_b32 s58, s64, 0
  s_sub_u32 s65, s65, s58
  s_cmp_ge_u32 s65, s64
  s_cselect_b32 s58, s64, 0
  s_sub_u32 s65, s65, s58
  s_cmp_ge_u32 s65, s64
  s_cselect_b32 s58, s64, 0
  s_sub_u32 s65, s65, s58
  s_cmp_ge_u32 s65, s64
  s_cselect_b32 s58, s64, 0
  s_sub_u32 s65, s65, s58
  s_cmp_ge_u32 s65, s64
  s_cselect_b32 s58, s64, 0
  s_sub_u32 s65, s65, s58
  s_cmp_ge_u32 s65, s64
  s_cselect_b32 s58, s64, 0
  s_sub_u32 s65, s65, s58
  s_cmp_ge_u32 s65, s64
  s_cselect_b32 s58, s64, 0
  s_sub_u32 s65, s65, s58
  s_cmp_ge_u32 s65, s64
  s_cselect_b32 s58, s64, 0
  s_sub_u32 s65, s65, s58
  s_add_u32 s58, s65, 0
  s_cmp_ge_u32 s58, s64
  s_cselect_b32 s59, s64, 0
  s_sub_u32 s58, s58, s59
  s_mul_i32 s72, s58, 2880
  s_add_u32 s72, s72, s74
  buffer_load_dwordx4 v[64:67], v60, s[8:11], s72 offen sc1
  buffer_load_dwordx2 v[76:77], v61, s[8:11], s72 offen offset:1024 sc1
  buffer_load_dwordx4 v[68:71], v62, s[8:11], s72 offen offset:1536 sc1
  buffer_load_dwordx4 v[72:75], v62, s[8:11], s72 offen offset:2208 sc1
  s_add_u32 s72, s72, 2880
  s_cmp_ge_u32 s72, s73
  s_cselect_b32 s72, s74, s72
  buffer_load_dwordx4 v[80:83], v60, s[8:11], s72 offen sc1
  buffer_load_dwordx2 v[92:93], v61, s[8:11], s72 offen offset:1024 sc1
  buffer_load_dwordx4 v[84:87], v62, s[8:11], s72 offen offset:1536 sc1
  buffer_load_dwordx4 v[88:91], v62, s[8:11], s72 offen offset:2208 sc1
  s_add_u32 s72, s72, 2880
  s_cmp_ge_u32 s72, s73
  s_cselect_b32 s72, s74, s72
  buffer_load_dwordx4 v[96:99], v60, s[8:11], s72 offen sc1
  buffer_load_dwordx2 v[108:109], v61, s[8:11], s72 offen offset:1024 sc1
  buffer_load_dwordx4 v[100:103], v62, s[8:11], s72 offen offset:1536 sc1
  buffer_load_dwordx4 v[104:107], v62, s[8:11], s72 offen offset:2208 sc1
  s_add_u32 s72, s72, 2880
  s_cmp_ge_u32 s72, s73
  s_cselect_b32 s72, s74, s72
  v_accvgpr_write_b32 a0, 0
  v_accvgpr_write_b32 a1, 0
  v_accvgpr_write_b32 a2, 0
  v_accvgpr_write_b32 a3, 0
  v_accvgpr_write_b32 a4, 0
  v_accvgpr_write_b32 a5, 0
  v_accvgpr_write_b32 a6, 0
  v_accvgpr_write_b32 a7, 0
  v_accvgpr_write_b32 a8, 0
  v_accvgpr_write_b32 a9, 0
  v_accvgpr_write_b32 a10, 0
  v_accvgpr_write_b32 a11, 0
  v_accvgpr_write_b32 a12, 0
  v_accvgpr_write_b32 a13, 0
  v_accvgpr_write_b32 a14, 0
  v_accvgpr_write_b32 a15, 0
  v_accvgpr_write_b32 a16, 0
  v_accvgpr_write_b32 a17, 0
  v_accvgpr_write_b32 a18, 0
  v_accvgpr_write_b32 a19, 0
  v_accvgpr_write_b32 a20, 0
  v_accvgpr_write_b32 a21, 0
  v_accvgpr_write_b32 a22, 0
  v_accvgpr_write_b32 a23, 0
  v_accvgpr_write_b32 a24, 0
  v_accvgpr_write_b32 a25, 0
  v_accvgpr_write_b32 a26, 0
  v_accvgpr_write_b32 a27, 0
  v_accvgpr_write_b32 a28, 0
  v_accvgpr_write_b32 a29, 0
  v_accvgpr_write_b32 a30, 0
  v_accvgpr_write_b32 a31, 0
  v_accvgpr_write_b32 a32, 0
  v_accvgpr_write_b32 a33, 0
  v_accvgpr_write_b32 a34, 0
  v_accvgpr_write_b32 a35, 0
  v_accvgpr_write_b32 a36, 0
  v_accvgpr_write_b32 a37, 0
  v_accvgpr_write_b32 a38, 0
  v_accvgpr_write_b32 a39, 0
  v_accvgpr_write_b32 a40, 0
  v_accvgpr_write_b32 a41, 0
  v_accvgpr_write_b32 a42, 0
  v_accvgpr_write_b32 a43, 0
  v_accvgpr_write_b32 a44, 0
  v_accvgpr_write_b32 a45, 0
  v_accvgpr_write_b32 a46, 0
  v_accvgpr_write_b32 a47, 0
  v_accvgpr_write_b32 a48, 0
  v_accvgpr_write_b32 a49, 0
  v_accvgpr_write_b32 a50, 0
  v_accvgpr_write_b32 a51, 0
  v_accvgpr_write_b32 a52, 0
  v_accvgpr_write_b32 a53, 0
  v_accvgpr_write_b32 a54, 0
  v_accvgpr_write_b32 a55, 0
  v_accvgpr_write_b32 a56, 0
  v_accvgpr_write_b32 a57, 0
  v_accvgpr_write_b32 a58, 0
  v_accvgpr_write_b32 a59, 0
  v_accvgpr_write_b32 a60, 0
  v_accvgpr_write_b32 a61, 0
  v_accvgpr_write_b32 a62, 0
  v_accvgpr_write_b32 a63, 0
  s_lshr_b32 s68, s64, 1
  s_cmp_lt_u32 s3, 4
  s_cselect_b32 s84, 1, 0
  s_mov_b32 s67, 1
  s_lshr_b32 s75, s64, 1
  s_cmp_ge_u32 s3, 2
  s_cbranch_scc1 nj_102
  s_cmp_gt_u32 s69, 320
  s_cbranch_scc1 nj_102
  s_mov_b32 s67, 0
  s_mov_b32 s75, 2
  s_add_u32 s68, s68, 100
nj_102:
attn_103:
  v_mov_b32 v56, 0
  v_mov_b32 v120, 0
  v_mov_b32 v57, 0
  v_mov_b32 v121, 0
  v_mov_b32 v58, 0
  v_mov_b32 v122, 0
  v_mov_b32 v59, 0
  v_mov_b32 v123, 0
  s_waitcnt vmcnt(8)
  v_mfma_f32_32x32x16_bf16 v[16:31], v[64:67], a[64:67], 0
  v_mfma_f32_32x32x8_bf16 v[16:31], v[76:77], a[80:81], v[16:31]
  s_cmp_eq_u32 s84, 0
  s_cbranch_scc1 ph_105
  s_mov_b32 s84, 0
ph_105:
  s_nop 9
attn_loop_106:
  s_waitcnt lgkmcnt(0)
  v_readfirstlane_b32 s56, v63
  v_mov_b32 v10, s68
  s_cmp_ge_u32 s68, s56
  s_cbranch_scc1 pr_110
  s_setprio 0
  s_branch pr_109
pr_110:
  s_setprio 1
pr_109:
  ds_write_b32 v8, v10
  ds_read_b32 v63, v9
  s_sub_u32 s68, s68, 1
  v_mfma_f32_32x32x16_bf16 v[32:47], v[64:67], a[68:71], 0
  v_exp_f32 v16, v16
  v_exp_f32 v17, v17
  v_exp_f32 v18, v18
  v_exp_f32 v19, v19
  v_mfma_f32_32x32x8_bf16 v[32:47], v[76:77], a[82:83], v[32:47]
  v_exp_f32 v20, v20
  v_cvt_pk_bf16_f32 v48, v16, v17
  v_exp_f32 v21, v21
  v_cvt_pk_bf16_f32 v49, v18, v19
  v_exp_f32 v22, v22
  v_exp_f32 v23, v23
  v_mfma_f32_32x32x16_bf16 a[48:63], v[120:123], v[56:59], a[48:63]
  buffer_load_dwordx4 v[112:115], v60, s[8:11], s72 offen sc1
  buffer_load_dwordx2 v[124:125], v61, s[8:11], s72 offen offset:1024 sc1
  buffer_load_dwordx4 v[116:119], v62, s[8:11], s72 offen offset:1536 sc1
  buffer_load_dwordx4 v[120:123], v62, s[8:11], s72 offen offset:2208 sc1
  s_add_u32 s72, s72, 2880
  s_cmp_ge_u32 s72, s73
  s_cselect_b32 s72, s74, s72
  v_exp_f32 v24, v24
  v_cvt_pk_bf16_f32 v50, v20, v21
  v_exp_f32 v25, v25
  v_cvt_pk_bf16_f32 v51, v22, v23
  v_exp_f32 v26, v26
  v_exp_f32 v27, v27
  v_mfma_f32_32x32x16_bf16 a[0:15], v[68:71], v[48:51], a[0:15]
  v_exp_f32 v28, v28
  v_cvt_pk_bf16_f32 v52, v24, v25
  v_exp_f32 v29, v29
  v_cvt_pk_bf16_f32 v53, v26, v27
  v_exp_f32 v30, v30
  v_cvt_pk_bf16_f32 v54, v28, v29
  v_exp_f32 v31, v31
  s_nop 0
  v_cvt_pk_bf16_f32 v55, v30, v31
  v_mfma_f32_32x32x16_bf16 v[16:31], v[64:67], a[72:75], 0
  v_exp_f32 v32, v32
  v_exp_f32 v33, v33
  v_exp_f32 v34, v34
  v_exp_f32 v35, v35
  v_mfma_f32_32x32x8_bf16 v[16:31], v[76:77], a[84:85], v[16:31]
  v_exp_f32 v36, v36
  v_cvt_pk_bf16_f32 v48, v32, v33
  v_exp_f32 v37, v37
  v_cvt_pk_bf16_f32 v49, v34, v35
  v_exp_f32 v38, v38
  v_exp_f32 v39, v39
  v_mfma_f32_32x32x16_bf16 a[0:15], v[72:75], v[52:55], a[0:15]
  v_exp_f32 v40, v40
  v_cvt_pk_bf16_f32 v50, v36, v37
  v_exp_f32 v41, v41
  v_cvt_pk_bf16_f32 v51, v38, v39
  v_exp_f32 v42, v42
  v_exp_f32 v43, v43
  v_mfma_f32_32x32x16_bf16 a[16:31], v[68:71], v[48:51], a[16:31]
  v_exp_f32 v44, v44
  v_cvt_pk_bf16_f32 v56, v40, v41
  v_exp_f32 v45, v45
  v_cvt_pk_bf16_f32 v57, v42, v43
  v_exp_f32 v46, v46
  v_cvt_pk_bf16_f32 v58, v44, v45
  v_exp_f32 v47, v47
  s_nop 0
  v_cvt_pk_bf16_f32 v59, v46, v47
  v_mfma_f32_32x32x16_bf16 v[32:47], v[64:67], a[76:79], 0
  v_exp_f32 v16, v16
  v_exp_f32 v17, v17
  v_exp_f32 v18, v18
  v_exp_f32 v19, v19
  v_mfma_f32_32x32x8_bf16 v[32:47], v[76:77], a[86:87], v[32:47]
  v_exp_f32 v20, v20
  v_cvt_pk_bf16_f32 v48, v16, v17
  v_exp_f32 v21, v21
  v_cvt_pk_bf16_f32 v49, v18, v19
  v_exp_f32 v22, v22
  v_exp_f32 v23, v23
  v_mfma_f32_32x32x16_bf16 a[16:31], v[72:75], v[56:59], a[16:31]
  v_exp_f32 v24, v24
  v_cvt_pk_bf16_f32 v50, v20, v21
  v_exp_f32 v25, v25
  v_cvt_pk_bf16_f32 v51, v22, v23
  v_exp_f32 v26, v26
  v_exp_f32 v27, v27
  v_mfma_f32_32x32x16_bf16 a[32:47], v[68:71], v[48:51], a[32:47]
  v_exp_f32 v28, v28
  v_cvt_pk_bf16_f32 v52, v24, v25
  v_exp_f32 v29, v29
  v_cvt_pk_bf16_f32 v53, v26, v27
  v_exp_f32 v30, v30
  v_cvt_pk_bf16_f32 v54, v28, v29
  v_exp_f32 v31, v31
  s_nop 0
  v_cvt_pk_bf16_f32 v55, v30, v31
  s_waitcnt vmcnt(8)
  v_mfma_f32_32x32x16_bf16 v[16:31], v[80:83], a[64:67], 0
  v_exp_f32 v32, v32
  v_exp_f32 v33, v33
  v_exp_f32 v34, v34
  v_exp_f32 v35, v35
  v_mfma_f32_32x32x8_bf16 v[16:31], v[92:93], a[80:81], v[16:31]
  v_exp_f32 v36, v36
  v_cvt_pk_bf16_f32 v48, v32, v33
  v_exp_f32 v37, v37
  v_cvt_pk_bf16_f32 v49, v34, v35
  v_exp_f32 v38, v38
  v_exp_f32 v39, v39
  v_mfma_f32_32x32x16_bf16 a[32:47], v[72:75], v[52:55], a[32:47]
  v_exp_f32 v40, v40
  v_cvt_pk_bf16_f32 v50, v36, v37
  v_exp_f32 v41, v41
  v_cvt_pk_bf16_f32 v51, v38, v39
  v_exp_f32 v42, v42
  v_exp_f32 v43, v43
  v_mfma_f32_32x32x16_bf16 a[48:63], v[68:71], v[48:51], a[48:63]
  v_exp_f32 v44, v44
  v_cvt_pk_bf16_f32 v56, v40, v41
  v_exp_f32 v45, v45
  v_cvt_pk_bf16_f32 v57, v42, v43
  v_exp_f32 v46, v46
  v_cvt_pk_bf16_f32 v58, v44, v45
  v_exp_f32 v47, v47
  s_nop 0
  v_cvt_pk_bf16_f32 v59, v46, v47
  v_mfma_f32_32x32x16_bf16 v[32:47], v[80:83], a[68:71], 0
  v_exp_f32 v16, v16
  v_exp_f32 v17, v17
  v_exp_f32 v18, v18
  v_exp_f32 v19, v19
  v_mfma_f32_32x32x8_bf16 v[32:47], v[92:93], a[82:83], v[32:47]
  v_exp_f32 v20, v20
  v_cvt_pk_bf16_f32 v48, v16, v17
  v_exp_f32 v21, v21
  v_cvt_pk_bf16_f32 v49, v18, v19
  v_exp_f32 v22, v22
  v_exp_f32 v23, v23
  v_mfma_f32_32x32x16_bf16 a[48:63], v[72:75], v[56:59], a[48:63]
  buffer_load_dwordx4 v[64:67], v60, s[8:11], s72 offen sc1
  buffer_load_dwordx2 v[76:77], v61, s[8:11], s72 offen offset:1024 sc1
  buffer_load_dwordx4 v[68:71], v62, s[8:11], s72 offen offset:1536 sc1
  buffer_load_dwordx4 v[72:75], v62, s[8:11], s72 offen offset:2208 sc1
  s_add_u32 s72, s72, 2880
  s_cmp_ge_u32 s72, s73
  s_cselect_b32 s72, s74, s72
  v_exp_f32 v24, v24
  v_cvt_pk_bf16_f32 v50, v20, v21
  v_exp_f32 v25, v25
  v_cvt_pk_bf16_f32 v51, v22, v23
  v_exp_f32 v26, v26
  v_exp_f32 v27, v27
  v_mfma_f32_32x32x16_bf16 a[0:15], v[84:87], v[48:51], a[0:15]
  v_exp_f32 v28, v28
  v_cvt_pk_bf16_f32 v52, v24, v25
  v_exp_f32 v29, v29
  v_cvt_pk_bf16_f32 v53, v26, v27
  v_exp_f32 v30, v30
  v_cvt_pk_bf16_f32 v54, v28, v29
  v_exp_f32 v31, v31
  s_nop 0
  v_cvt_pk_bf16_f32 v55, v30, v31
  v_mfma_f32_32x32x16_bf16 v[16:31], v[80:83], a[72:75], 0
  v_exp_f32 v32, v32
  v_exp_f32 v33, v33
  v_exp_f32 v34, v34
  v_exp_f32 v35, v35
  v_mfma_f32_32x32x8_bf16 v[16:31], v[92:93], a[84:85], v[16:31]
  v_exp_f32 v36, v36
  v_cvt_pk_bf16_f32 v48, v32, v33
  v_exp_f32 v37, v37
  v_cvt_pk_bf16_f32 v49, v34, v35
  v_exp_f32 v38, v38
  v_exp_f32 v39, v39
  v_mfma_f32_32x32x16_bf16 a[0:15], v[88:91], v[52:55], a[0:15]
  v_exp_f32 v40, v40
  v_cvt_pk_bf16_f32 v50, v36, v37
  v_exp_f32 v41, v41
  v_cvt_pk_bf16_f32 v51, v38, v39
  v_exp_f32 v42, v42
  v_exp_f32 v43, v43
  v_mfma_f32_32x32x16_bf16 a[16:31], v[84:87], v[48:51], a[16:31]
  v_exp_f32 v44, v44
  v_cvt_pk_bf16_f32 v56, v40, v41
  v_exp_f32 v45, v45
  v_cvt_pk_bf16_f32 v57, v42, v43
  v_exp_f32 v46, v46
  v_cvt_pk_bf16_f32 v58, v44, v45
  v_exp_f32 v47, v47
  s_nop 0
  v_cvt_pk_bf16_f32 v59, v46, v47
  v_mfma_f32_32x32x16_bf16 v[32:47], v[80:83], a[76:79], 0
  v_exp_f32 v16, v16
  v_exp_f32 v17, v17
  v_exp_f32 v18, v18
  v_exp_f32 v19, v19
  v_mfma_f32_32x32x8_bf16 v[32:47], v[92:93], a[86:87], v[32:47]
  v_exp_f32 v20, v20
  v_cvt_pk_bf16_f32 v48, v16, v17
  v_exp_f32 v21, v21
  v_cvt_pk_bf16_f32 v49, v18, v19
  v_exp_f32 v22, v22
  v_exp_f32 v23, v23
  v_mfma_f32_32x32x16_bf16 a[16:31], v[88:91], v[56:59], a[16:31]
  v_exp_f32 v24, v24
  v_cvt_pk_bf16_f32 v50, v20, v21
  v_exp_f32 v25, v25
  v_cvt_pk_bf16_f32 v51, v22, v23
  v_exp_f32 v26, v26
  v_exp_f32 v27, v27
  v_mfma_f32_32x32x16_bf16 a[32:47], v[84:87], v[48:51], a[32:47]
  v_exp_f32 v28, v28
  v_cvt_pk_bf16_f32 v52, v24, v25
  v_exp_f32 v29, v29
  v_cvt_pk_bf16_f32 v53, v26, v27
  v_exp_f32 v30, v30
  v_cvt_pk_bf16_f32 v54, v28, v29
  v_exp_f32 v31, v31
  s_nop 0
  v_cvt_pk_bf16_f32 v55, v30, v31
  s_waitcnt vmcnt(8)
  v_mfma_f32_32x32x16_bf16 v[16:31], v[96:99], a[64:67], 0
  v_exp_f32 v32, v32
  v_exp_f32 v33, v33
  v_exp_f32 v34, v34
  v_exp_f32 v35, v35
  v_mfma_f32_32x32x8_bf16 v[16:31], v[108:109], a[80:81], v[16:31]
  v_exp_f32 v36, v36
  v_cvt_pk_bf16_f32 v48, v32, v33
  v_exp_f32 v37, v37
  v_cvt_pk_bf16_f32 v49, v34, v35
  v_exp_f32 v38, v38
  v_exp_f32 v39, v39
  v_mfma_f32_32x32x16_bf16 a[32:47], v[88:91], v[52:55], a[32:47]
  v_exp_f32 v40, v40
  v_cvt_pk_bf16_f32 v50, v36, v37
  v_exp_f32 v41, v41
  v_cvt_pk_bf16_f32 v51, v38, v39
  v_exp_f32 v42, v42
  v_exp_f32 v43, v43
  v_mfma_f32_32x32x16_bf16 a[48:63], v[84:87], v[48:51], a[48:63]
  v_exp_f32 v44, v44
  v_cvt_pk_bf16_f32 v56, v40, v41
  v_exp_f32 v45, v45
  v_cvt_pk_bf16_f32 v57, v42, v43
  v_exp_f32 v46, v46
  v_cvt_pk_bf16_f32 v58, v44, v45
  v_exp_f32 v47, v47
  s_nop 0
  v_cvt_pk_bf16_f32 v59, v46, v47
  s_sub_u32 s75, s75, 1
  s_cmp_eq_u32 s75, 0
  s_cbranch_scc1 attn_mid_107
  s_waitcnt lgkmcnt(0)
  v_readfirstlane_b32 s56, v63
  v_mov_b32 v10, s68
  s_cmp_ge_u32 s68, s56
  s_cbranch_scc1 pr_112
  s_setprio 0
  s_branch pr_111
pr_112:
  s_setprio 1
pr_111:
  ds_write_b32 v8, v10
  ds_read_b32 v63, v9
  s_sub_u32 s68, s68, 1
  v_mfma_f32_32x32x16_bf16 v[32:47], v[96:99], a[68:71], 0
  v_exp_f32 v16, v16
  v_exp_f32 v17, v17
  v_exp_f32 v18, v18
  v_exp_f32 v19, v19
  v_mfma_f32_32x32x8_bf16 v[32:47], v[108:109], a[82:83], v[32:47]
  v_exp_f32 v20, v20
  v_cvt_pk_bf16_f32 v48, v16, v17
  v_exp_f32 v21, v21
  v_cvt_pk_bf16_f32 v49, v18, v19
  v_exp_f32 v22, v22
  v_exp_f32 v23, v23
  v_mfma_f32_32x32x16_bf16 a[48:63], v[88:91], v[56:59], a[48:63]
  buffer_load_dwordx4 v[80:83], v60, s[8:11], s72 offen sc1
  buffer_load_dwordx2 v[92:93], v61, s[8:11], s72 offen offset:1024 sc1
  buffer_load_dwordx4 v[84:87], v62, s[8:11], s72 offen offset:1536 sc1
  buffer_load_dwordx4 v[88:91], v62, s[8:11], s72 offen offset:2208 sc1
  s_add_u32 s72, s72, 2880
  s_cmp_ge_u32 s72, s73
  s_cselect_b32 s72, s74, s72
  v_exp_f32 v24, v24
  v_cvt_pk_bf16_f32 v50, v20, v21
  v_exp_f32 v25, v25
  v_cvt_pk_bf16_f32 v51, v22, v23
  v_exp_f32 v26, v26
  v_exp_f32 v27, v27
  v_mfma_f32_32x32x16_bf16 a[0:15], v[100:103], v[48:51], a[0:15]
  v_exp_f32 v28, v28
  v_cvt_pk_bf16_f32 v52, v24, v25
  v_exp_f32 v29, v29
  v_cvt_pk_bf16_f32 v53, v26, v27
  v_exp_f32 v30, v30
  v_cvt_pk_bf16_f32 v54, v28, v29
  v_exp_f32 v31, v31
  s_nop 0
  v_cvt_pk_bf16_f32 v55, v30, v31
  v_mfma_f32_32x32x16_bf16 v[16:31], v[96:99], a[72:75], 0
  v_exp_f32 v32, v32
  v_exp_f32 v33, v33
  v_exp_f32 v34, v34
  v_exp_f32 v35, v35
  v_mfma_f32_32x32x8_bf16 v[16:31], v[108:109], a[84:85], v[16:31]
  v_exp_f32 v36, v36
  v_cvt_pk_bf16_f32 v48, v32, v33
  v_exp_f32 v37, v37
  v_cvt_pk_bf16_f32 v49, v34, v35
  v_exp_f32 v38, v38
  v_exp_f32 v39, v39
  v_mfma_f32_32x32x16_bf16 a[0:15], v[104:107], v[52:55], a[0:15]
  v_exp_f32 v40, v40
  v_cvt_pk_bf16_f32 v50, v36, v37
  v_exp_f32 v41, v41
  v_cvt_pk_bf16_f32 v51, v38, v39
  v_exp_f32 v42, v42
  v_exp_f32 v43, v43
  v_mfma_f32_32x32x16_bf16 a[16:31], v[100:103], v[48:51], a[16:31]
  v_exp_f32 v44, v44
  v_cvt_pk_bf16_f32 v56, v40, v41
  v_exp_f32 v45, v45
  v_cvt_pk_bf16_f32 v57, v42, v43
  v_exp_f32 v46, v46
  v_cvt_pk_bf16_f32 v58, v44, v45
  v_exp_f32 v47, v47
  s_nop 0
  v_cvt_pk_bf16_f32 v59, v46, v47
  v_mfma_f32_32x32x16_bf16 v[32:47], v[96:99], a[76:79], 0
  v_exp_f32 v16, v16
  v_exp_f32 v17, v17
  v_exp_f32 v18, v18
  v_exp_f32 v19, v19
  v_mfma_f32_32x32x8_bf16 v[32:47], v[108:109], a[86:87], v[32:47]
  v_exp_f32 v20, v20
  v_cvt_pk_bf16_f32 v48, v16, v17
  v_exp_f32 v21, v21
  v_cvt_pk_bf16_f32 v49, v18, v19
  v_exp_f32 v22, v22
  v_exp_f32 v23, v23
  v_mfma_f32_32x32x16_bf16 a[16:31], v[104:107], v[56:59], a[16:31]
  v_exp_f32 v24, v24
  v_cvt_pk_bf16_f32 v50, v20, v21
  v_exp_f32 v25, v25
  v_cvt_pk_bf16_f32 v51, v22, v23
  v_exp_f32 v26, v26
  v_exp_f32 v27, v27
  v_mfma_f32_32x32x16_bf16 a[32:47], v[100:103], v[48:51], a[32:47]
  v_exp_f32 v28, v28
  v_cvt_pk_bf16_f32 v52, v24, v25
  v_exp_f32 v29, v29
  v_cvt_pk_bf16_f32 v53, v26, v27
  v_exp_f32 v30, v30
  v_cvt_pk_bf16_f32 v54, v28, v29
  v_exp_f32 v31, v31
  s_nop 0
  v_cvt_pk_bf16_f32 v55, v30, v31
  s_waitcnt vmcnt(8)
  v_mfma_f32_32x32x16_bf16 v[16:31], v[112:115], a[64:67], 0
  v_exp_f32 v32, v32
  v_exp_f32 v33, v33
  v_exp_f32 v34, v34
  v_exp_f32 v35, v35
  v_mfma_f32_32x32x8_bf16 v[16:31], v[124:125], a[80:81], v[16:31]
  v_exp_f32 v36, v36
  v_cvt_pk_bf16_f32 v48, v32, v33
  v_exp_f32 v37, v37
  v_cvt_pk_bf16_f32 v49, v34, v35
  v_exp_f32 v38, v38
  v_exp_f32 v39, v39
  v_mfma_f32_32x32x16_bf16 a[32:47], v[104:107], v[52:55], a[32:47]
  v_exp_f32 v40, v40
  v_cvt_pk_bf16_f32 v50, v36, v37
  v_exp_f32 v41, v41
  v_cvt_pk_bf16_f32 v51, v38, v39
  v_exp_f32 v42, v42
  v_exp_f32 v43, v43
  v_mfma_f32_32x32x16_bf16 a[48:63], v[100:103], v[48:51], a[48:63]
  v_exp_f32 v44, v44
  v_cvt_pk_bf16_f32 v56, v40, v41
  v_exp_f32 v45, v45
  v_cvt_pk_bf16_f32 v57, v42, v43
  v_exp_f32 v46, v46
  v_cvt_pk_bf16_f32 v58, v44, v45
  v_exp_f32 v47, v47
  s_nop 0
  v_cvt_pk_bf16_f32 v59, v46, v47
  v_mfma_f32_32x32x16_bf16 v[32:47], v[112:115], a[68:71], 0
  v_exp_f32 v16, v16
  v_exp_f32 v17, v17
  v_exp_f32 v18, v18
  v_exp_f32 v19, v19
  v_mfma_f32_32x32x8_bf16 v[32:47], v[124:125], a[82:83], v[32:47]
  v_exp_f32 v20, v20
  v_cvt_pk_bf16_f32 v48, v16, v17
  v_exp_f32 v21, v21
  v_cvt_pk_bf16_f32 v49, v18, v19
  v_exp_f32 v22, v22
  v_exp_f32 v23, v23
  v_mfma_f32_32x32x16_bf16 a[48:63], v[104:107], v[56:59], a[48:63]
  buffer_load_dwordx4 v[96:99], v60, s[8:11], s72 offen sc1
  buffer_load_dwordx2 v[108:109], v61, s[8:11], s72 offen offset:1024 sc1
  buffer_load_dwordx4 v[100:103], v62, s[8:11], s72 offen offset:1536 sc1
  buffer_load_dwordx4 v[104:107], v62, s[8:11], s72 offen offset:2208 sc1
  s_add_u32 s72, s72, 2880
  s_cmp_ge_u32 s72, s73
  s_cselect_b32 s72, s74, s72
  v_exp_f32 v24, v24
  v_cvt_pk_bf16_f32 v50, v20, v21
  v_exp_f32 v25, v25
  v_cvt_pk_bf16_f32 v51, v22, v23
  v_exp_f32 v26, v26
  v_exp_f32 v27, v27
  v_mfma_f32_32x32x16_bf16 a[0:15], v[116:119], v[48:51], a[0:15]
  v_exp_f32 v28, v28
  v_cvt_pk_bf16_f32 v52, v24, v25
  v_exp_f32 v29, v29
  v_cvt_pk_bf16_f32 v53, v26, v27
  v_exp_f32 v30, v30
  v_cvt_pk_bf16_f32 v54, v28, v29
  v_exp_f32 v31, v31
  s_nop 0
  v_cvt_pk_bf16_f32 v55, v30, v31
  v_mfma_f32_32x32x16_bf16 v[16:31], v[112:115], a[72:75], 0
  v_exp_f32 v32, v32
  v_exp_f32 v33, v33
  v_exp_f32 v34, v34
  v_exp_f32 v35, v35
  v_mfma_f32_32x32x8_bf16 v[16:31], v[124:125], a[84:85], v[16:31]
  v_exp_f32 v36, v36
  v_cvt_pk_bf16_f32 v48, v32, v33
  v_exp_f32 v37, v37
  v_cvt_pk_bf16_f32 v49, v34, v35
  v_exp_f32 v38, v38
  v_exp_f32 v39, v39
  v_mfma_f32_32x32x16_bf16 a[0:15], v[120:123], v[52:55], a[0:15]
  v_exp_f32 v40, v40
  v_cvt_pk_bf16_f32 v50, v36, v37
  v_exp_f32 v41, v41
  v_cvt_pk_bf16_f32 v51, v38, v39
  v_exp_f32 v42, v42
  v_exp_f32 v43, v43
  v_mfma_f32_32x32x16_bf16 a[16:31], v[116:119], v[48:51], a[16:31]
  v_exp_f32 v44, v44
  v_cvt_pk_bf16_f32 v56, v40, v41
  v_exp_f32 v45, v45
  v_cvt_pk_bf16_f32 v57, v42, v43
  v_exp_f32 v46, v46
  v_cvt_pk_bf16_f32 v58, v44, v45
  v_exp_f32 v47, v47
  s_nop 0
  v_cvt_pk_bf16_f32 v59, v46, v47
  v_mfma_f32_32x32x16_bf16 v[32:47], v[112:115], a[76:79], 0
  v_exp_f32 v16, v16
  v_exp_f32 v17, v17
  v_exp_f32 v18, v18
  v_exp_f32 v19, v19
  v_mfma_f32_32x32x8_bf16 v[32:47], v[124:125], a[86:87], v[32:47]
  v_exp_f32 v20, v20
  v_cvt_pk_bf16_f32 v48, v16, v17
  v_exp_f32 v21, v21
  v_cvt_pk_bf16_f32 v49, v18, v19
  v_exp_f32 v22, v22
  v_exp_f32 v23, v23
  v_mfma_f32_32x32x16_bf16 a[16:31], v[120:123], v[56:59], a[16:31]
  v_exp_f32 v24, v24
  v_cvt_pk_bf16_f32 v50, v20, v21
  v_exp_f32 v25, v25
  v_cvt_pk_bf16_f32 v51, v22, v23
  v_exp_f32 v26, v26
  v_exp_f32 v27, v27
  v_mfma_f32_32x32x16_bf16 a[32:47], v[116:119], v[48:51], a[32:47]
  v_exp_f32 v28, v28
  v_cvt_pk_bf16_f32 v52, v24, v25
  v_exp_f32 v29, v29
  v_cvt_pk_bf16_f32 v53, v26, v27
  v_exp_f32 v30, v30
  v_cvt_pk_bf16_f32 v54, v28, v29
  v_exp_f32 v31, v31
  s_nop 0
  v_cvt_pk_bf16_f32 v55, v30, v31
  s_waitcnt vmcnt(8)
  v_mfma_f32_32x32x16_bf16 v[16:31], v[64:67], a[64:67], 0
  v_exp_f32 v32, v32
  v_exp_f32 v33, v33
  v_exp_f32 v34, v34
  v_exp_f32 v35, v35
  v_mfma_f32_32x32x8_bf16 v[16:31], v[76:77], a[80:81], v[16:31]
  v_exp_f32 v36, v36
  v_cvt_pk_bf16_f32 v48, v32, v33
  v_exp_f32 v37, v37
  v_cvt_pk_bf16_f32 v49, v34, v35
  v_exp_f32 v38, v38
  v_exp_f32 v39, v39
  v_mfma_f32_32x32x16_bf16 a[32:47], v[120:123], v[52:55], a[32:47]
  v_exp_f32 v40, v40
  v_cvt_pk_bf16_f32 v50, v36, v37
  v_exp_f32 v41, v41
  v_cvt_pk_bf16_f32 v51, v38, v39
  v_exp_f32 v42, v42
  v_exp_f32 v43, v43
  v_mfma_f32_32x32x16_bf16 a[48:63], v[116:119], v[48:51], a[48:63]
  v_exp_f32 v44, v44
  v_cvt_pk_bf16_f32 v56, v40, v41
  v_exp_f32 v45, v45
  v_cvt_pk_bf16_f32 v57, v42, v43
  v_exp_f32 v46, v46
  v_cvt_pk_bf16_f32 v58, v44, v45
  v_exp_f32 v47, v47
  s_nop 0
  v_cvt_pk_bf16_f32 v59, v46, v47
  s_sub_u32 s75, s75, 1
  s_cmp_lg_u32 s75, 0
  s_cbranch_scc1 attn_loop_106
  s_nop 1
  v_mfma_f32_32x32x16_bf16 a[48:63], v[120:123], v[56:59], a[48:63]
  s_branch attn_out_108
attn_mid_107:
  s_nop 1
  v_mfma_f32_32x32x16_bf16 a[48:63], v[88:91], v[56:59], a[48:63]
attn_out_108:
  s_waitcnt vmcnt(0)
  s_cmp_eq_u32 s67, 1
  s_cbranch_scc1 attn_104
  s_mov_b32 s67, 1
  s_setprio 1
  v_mov_b32 v16, 162820
  s_mov_b32 s88, 0
sp_113:
  ds_read_b32 v17, v16
  s_waitcnt lgkmcnt(0)
  v_readfirstlane_b32 s89, v17
  s_cmp_ge_u32 s89, 4
  s_cbranch_scc1 sp_114
  s_add_u32 s88, s88, 1
  s_cmp_ge_u32 s88, 0x100000
  s_cbranch_scc1 sp_114
  s_sleep 1
  s_branch sp_113
sp_114:
  v_lshlrev_b32 v104, 6, v1
  s_mov_b32 s91, 18055168
  s_mov_b32 s90, 0
poll_115:
  s_mov_b32 s92, s91
  buffer_load_dword v105, v104, s[8:11], s92 offen sc1
  s_add_u32 s92, s92, 4096
  buffer_load_dword v106, v104, s[8:11], s92 offen sc1
  s_add_u32 s92, s92, 4096
  buffer_load_dword v107, v104, s[8:11], s92 offen sc1
  s_add_u32 s92, s92, 4096
  buffer_load_dword v108, v104, s[8:11], s92 offen sc1
  s_waitcnt vmcnt(0)
  v_cmp_ne_u32 vcc, s50, v105
  s_mov_b64 s[94:95], vcc
  v_cmp_ne_u32 vcc, s50, v106
  s_or_b64 s[94:95], s[94:95], vcc
  v_cmp_ne_u32 vcc, s50, v107
  s_or_b64 s[94:95], s[94:95], vcc
  v_cmp_ne_u32 vcc, s50, v108
  s_or_b64 s[94:95], s[94:95], vcc
  s_cmp_eq_u64 s[94:95], 0
  s_cbranch_scc1 polld_116
  s_add_u32 s90, s90, 1
  s_cmp_ge_u32 s90, 0x40000
  s_cbranch_scc1 polld_116
  s_sleep 6
  s_branch poll_115
polld_116:
  s_lshl_b32 s66, s3, 13
  s_add_u32 s66, s66, 65536
  s_lshl_b32 s56, s69, 1
  s_cmp_eq_u32 s69, 320
  s_cselect_b32 s56, 1, s56
  s_cselect_b32 s58, 1, 0
  s_cmp_eq_u32 s69, 0
  s_cselect_b32 s58, 1, s58
  s_lshl_b32 s57, s69, 1
  s_add_u32 s57, s57, 1
  s_lshl_b32 s59, s56, 12
  s_add_u32 s59, s59, 6356992
  s_add_u32 m0, s66, 0
  s_nop 0
  buffer_load_dwordx4 v14, s[8:11], s59 offen sc1 lds
  s_add_u32 s59, s59, 1024
  s_add_u32 m0, s66, 1024
  s_nop 0
  buffer_load_dwordx4 v14, s[8:11], s59 offen sc1 lds
  s_add_u32 s59, s59, 1024
  s_add_u32 m0, s66, 2048
  s_nop 0
  buffer_load_dwordx4 v14, s[8:11], s59 offen sc1 lds
  s_add_u32 s59, s59, 1024
  s_add_u32 m0, s66, 3072
  s_nop 0
  buffer_load_dwordx4 v14, s[8:11], s59 offen sc1 lds
  s_add_u32 s59, s59, 1024
  s_cmp_eq_u32 s58, 1
  s_cbranch_scc1 ss_117
  s_lshl_b32 s59, s57, 12
  s_add_u32 s59, s59, 6356992
  s_add_u32 m0, s66, 4096
  s_nop 0
  buffer_load_dwordx4 v14, s[8:11], s59 offen sc1 lds
  s_add_u32 s59, s59, 1024
  s_add_u32 m0, s66, 5120
  s_nop 0
  buffer_load_dwordx4 v14, s[8:11], s59 offen sc1 lds
  s_add_u32 s59, s59, 1024
  s_add_u32 m0, s66, 6144
  s_nop 0
  buffer_load_dwordx4 v14, s[8:11], s59 offen sc1 lds
  s_add_u32 s59, s59, 1024
  s_add_u32 m0, s66, 7168
  s_nop 0
  buffer_load_dwordx4 v14, s[8:11], s59 offen sc1 lds
  s_add_u32 s59, s59, 1024
ss_117:
  s_lshl_b32 s59, s69, 13
  s_add_u32 s59, s59, 12648448
  buffer_load_dwordx4 a[88:91], v14, s[8:11], s59 offen offset:0 sc1
  buffer_load_dwordx4 a[92:95], v14, s[8:11], s59 offen offset:1024 sc1
  buffer_load_dwordx4 a[96:99], v14, s[8:11], s59 offen offset:2048 sc1
  buffer_load_dwordx4 a[100:103], v14, s[8:11], s59 offen offset:3072 sc1
  s_add_u32 s59, s59, 4096
  buffer_load_dwordx4 a[104:107], v14, s[8:11], s59 offen offset:0 sc1
  buffer_load_dwordx4 a[108:111], v14, s[8:11], s59 offen offset:1024 sc1
  buffer_load_dwordx4 a[112:115], v14, s[8:11], s59 offen offset:2048 sc1
  buffer_load_dwordx4 a[116:119], v14, s[8:11], s59 offen offset:3072 sc1
  v_and_b32 v11, 15, v1
  v_lshrrev_b32 v12, 2, v11
  v_lshl_add_u32 v12, v5, 2, v12
  v_lshlrev_b32 v12, 7, v12
  v_and_b32 v11, 3, v11
  v_lshl_add_u32 v12, v11, 3, v12
  v_bfe_u32 v11, v1, 4, 1
  v_lshl_add_u32 v12, v11, 5, v12
  v_add_u32 v12, s66, v12
  ds_read_b128 a[120:123], v14 offset:32768
  ds_read_b128 a[124:127], v14 offset:33792
  ds_read_b128 v[16:19], v14 offset:34816
  ds_read_b128 v[20:23], v14 offset:35840
  ds_read_b128 v[24:27], v14 offset:36864
  ds_read_b128 v[28:31], v14 offset:37888
  s_waitcnt vmcnt(8)
  ds_read_b64_tr_b16 v[32:33], v12 offset:0
  ds_read_b64_tr_b16 v[34:35], v12 offset:1024
  ds_read_b64_tr_b16 v[36:37], v12 offset:2048
  ds_read_b64_tr_b16 v[38:39], v12 offset:3072
  ds_read_b64_tr_b16 v[48:49], v12 offset:64
  ds_read_b64_tr_b16 v[50:51], v12 offset:1088
  ds_read_b64_tr_b16 v[52:53], v12 offset:2112
  ds_read_b64_tr_b16 v[54:55], v12 offset:3136
  s_waitcnt lgkmcnt(0)
  s_cmp_eq_u32 s58, 1
  s_cbranch_scc1 ss_118
  ds_read_b64_tr_b16 v[40:41], v12 offset:4096
  ds_read_b64_tr_b16 v[42:43], v12 offset:5120
  ds_read_b64_tr_b16 v[44:45], v12 offset:6144
  ds_read_b64_tr_b16 v[46:47], v12 offset:7168
  ds_read_b64_tr_b16 v[56:57], v12 offset:4160
  ds_read_b64_tr_b16 v[58:59], v12 offset:5184
  ds_read_b64_tr_b16 v[60:61], v12 offset:6208
  ds_read_b64_tr_b16 v[62:63], v12 offset:7232
  s_branch ss_118_j
ss_118:
  v_mov_b32 v40, 0
  v_mov_b32 v41, 0
  v_mov_b32 v42, 0
  v_mov_b32 v43, 0
  v_mov_b32 v44, 0
  v_mov_b32 v45, 0
  v_mov_b32 v46, 0
  v_mov_b32 v47, 0
  v_mov_b32 v56, 0
  v_mov_b32 v57, 0
  v_mov_b32 v58, 0
  v_mov_b32 v59, 0
  v_mov_b32 v60, 0
  v_mov_b32 v61, 0
  v_mov_b32 v62, 0
  v_mov_b32 v63, 0
ss_118_j:
  s_waitcnt lgkmcnt(0)
  s_nop 1
  v_mfma_f32_32x32x16_bf16 v[64:79], v[32:35], a[120:123], 0
  v_mfma_f32_32x32x16_bf16 v[80:95], v[40:43], a[120:123], 0
  v_mfma_f32_32x32x16_bf16 v[64:79], v[36:39], a[124:127], v[64:79]
  v_mfma_f32_32x32x16_bf16 v[80:95], v[44:47], a[124:127], v[80:95]
  v_mfma_f32_32x32x16_bf16 v[64:79], v[40:43], v[16:19], v[64:79]
  v_mfma_f32_32x32x16_bf16 v[80:95], v[32:35], v[24:27], v[80:95]
  v_mfma_f32_32x32x16_bf16 v[64:79], v[44:47], v[20:23], v[64:79]
  v_mfma_f32_32x32x16_bf16 v[80:95], v[36:39], v[28:31], v[80:95]
  v_mfma_f32_32x32x16_bf16 v[96:111], v[48:51], a[120:123], 0
  v_mfma_f32_32x32x16_bf16 v[112:127], v[56:59], a[120:123], 0
  v_mfma_f32_32x32x16_bf16 v[96:111], v[52:55], a[124:127], v[96:111]
  v_mfma_f32_32x32x16_bf16 v[112:127], v[60:63], a[124:127], v[112:127]
  v_mfma_f32_32x32x16_bf16 v[96:111], v[56:59], v[16:19], v[96:111]
  v_mfma_f32_32x32x16_bf16 v[112:127], v[48:51], v[24:27], v[112:127]
  v_mfma_f32_32x32x16_bf16 v[96:111], v[60:63], v[20:23], v[96:111]
  v_mfma_f32_32x32x16_bf16 v[112:127], v[52:55], v[28:31], v[112:127]
  s_nop 3
  ds_read_b128 v[16:19], v14 offset:0
  ds_read_b128 v[20:23], v14 offset:1024
  ds_read_b128 v[24:27], v14 offset:2048
  ds_read_b128 v[28:31], v14 offset:3072
  s_waitcnt lgkmcnt(2)
  v_pk_mul_f32 v[32:33], v[80:81], v[20:21]
  v_pk_mul_f32 v[40:41], v[64:65], v[20:21]
  v_pk_fma_f32 v[64:65], v[64:65], v[16:17], v[32:33]
  v_pk_fma_f32 v[80:81], v[80:81], v[16:17], v[40:41] neg_lo:[0,0,1] neg_hi:[0,0,1]
  v_pk_mul_f32 v[32:33], v[82:83], v[22:23]
  v_pk_mul_f32 v[40:41], v[66:67], v[22:23]
  v_pk_fma_f32 v[66:67], v[66:67], v[18:19], v[32:33]
  v_pk_fma_f32 v[82:83], v[82:83], v[18:19], v[40:41] neg_lo:[0,0,1] neg_hi:[0,0,1]
  ds_read_b128 v[16:19], v14 offset:4096
  ds_read_b128 v[20:23], v14 offset:5120
  s_waitcnt lgkmcnt(2)
  v_pk_mul_f32 v[34:35], v[84:85], v[28:29]
  v_pk_mul_f32 v[42:43], v[68:69], v[28:29]
  v_pk_fma_f32 v[68:69], v[68:69], v[24:25], v[34:35]
  v_pk_fma_f32 v[84:85], v[84:85], v[24:25], v[42:43] neg_lo:[0,0,1] neg_hi:[0,0,1]
  v_pk_mul_f32 v[34:35], v[86:87], v[30:31]
  v_pk_mul_f32 v[42:43], v[70:71], v[30:31]
  v_pk_fma_f32 v[70:71], v[70:71], v[26:27], v[34:35]
  v_pk_fma_f32 v[86:87], v[86:87], v[26:27], v[42:43] neg_lo:[0,0,1] neg_hi:[0,0,1]
  ds_read_b128 v[24:27], v14 offset:6144
  ds_read_b128 v[28:31], v14 offset:7168
  s_waitcnt lgkmcnt(2)
  v_pk_mul_f32 v[36:37], v[88:89], v[20:21]
  v_pk_mul_f32 v[44:45], v[72:73], v[20:21]
  v_pk_fma_f32 v[72:73], v[72:73], v[16:17], v[36:37]
  v_pk_fma_f32 v[88:89], v[88:89], v[16:17], v[44:45] neg_lo:[0,0,1] neg_hi:[0,0,1]
  v_pk_mul_f32 v[36:37], v[90:91], v[22:23]
  v_pk_mul_f32 v[44:45], v[74:75], v[22:23]
  v_pk_fma_f32 v[74:75], v[74:75], v[18:19], v[36:37]
  v_pk_fma_f32 v[90:91], v[90:91], v[18:19], v[44:45] neg_lo:[0,0,1] neg_hi:[0,0,1]
  ds_read_b128 v[16:19], v14 offset:8192
  ds_read_b128 v[20:23], v14 offset:9216
  s_waitcnt lgkmcnt(2)
  v_pk_mul_f32 v[38:39], v[92:93], v[28:29]
  v_pk_mul_f32 v[46:47], v[76:77], v[28:29]
  v_pk_fma_f32 v[76:77], v[76:77], v[24:25], v[38:39]
  v_pk_fma_f32 v[92:93], v[92:93], v[24:25], v[46:47] neg_lo:[0,0,1] neg_hi:[0,0,1]
  v_pk_mul_f32 v[38:39], v[94:95], v[30:31]
  v_pk_mul_f32 v[46:47], v[78:79], v[30:31]
  v_pk_fma_f32 v[78:79], v[78:79], v[26:27], v[38:39]
  v_pk_fma_f32 v[94:95], v[94:95], v[26:27], v[46:47] neg_lo:[0,0,1] neg_hi:[0,0,1]
  ds_read_b128 v[24:27], v14 offset:10240
  ds_read_b128 v[28:31], v14 offset:11264
  s_waitcnt lgkmcnt(2)
  v_pk_mul_f32 v[48:49], v[112:113], v[20:21]
  v_pk_mul_f32 v[56:57], v[96:97], v[20:21]
  v_pk_fma_f32 v[96:97], v[96:97], v[16:17], v[48:49]
  v_pk_fma_f32 v[112:113], v[112:113], v[16:17], v[56:57] neg_lo:[0,0,1] neg_hi:[0,0,1]
  v_pk_mul_f32 v[48:49], v[114:115], v[22:23]
  v_pk_mul_f32 v[56:57], v[98:99], v[22:23]
  v_pk_fma_f32 v[98:99], v[98:99], v[18:19], v[48:49]
  v_pk_fma_f32 v[114:115], v[114:115], v[18:19], v[56:57] neg_lo:[0,0,1] neg_hi:[0,0,1]
  ds_read_b128 v[16:19], v14 offset:12288
  ds_read_b128 v[20:23], v14 offset:13312
  s_waitcnt lgkmcnt(2)
  v_pk_mul_f32 v[50:51], v[116:117], v[28:29]
  v_pk_mul_f32 v[58:59], v[100:101], v[28:29]
  v_pk_fma_f32 v[100:101], v[100:101], v[24:25], v[50:51]
  v_pk_fma_f32 v[116:117], v[116:117], v[24:25], v[58:59] neg_lo:[0,0,1] neg_hi:[0,0,1]
  v_pk_mul_f32 v[50:51], v[118:119], v[30:31]
  v_pk_mul_f32 v[58:59], v[102:103], v[30:31]
  v_pk_fma_f32 v[102:103], v[102:103], v[26:27], v[50:51]
  v_pk_fma_f32 v[118:119], v[118:119], v[26:27], v[58:59] neg_lo:[0,0,1] neg_hi:[0,0,1]
  ds_read_b128 v[24:27], v14 offset:14336
  ds_read_b128 v[28:31], v14 offset:15360
  s_waitcnt lgkmcnt(2)
  v_pk_mul_f32 v[52:53], v[120:121], v[20:21]
  v_pk_mul_f32 v[60:61], v[104:105], v[20:21]
  v_pk_fma_f32 v[104:105], v[104:105], v[16:17], v[52:53]
  v_pk_fma_f32 v[120:121], v[120:121], v[16:17], v[60:61] neg_lo:[0,0,1] neg_hi:[0,0,1]
  v_pk_mul_f32 v[52:53], v[122:123], v[22:23]
  v_pk_mul_f32 v[60:61], v[106:107], v[22:23]
  v_pk_fma_f32 v[106:107], v[106:107], v[18:19], v[52:53]
  v_pk_fma_f32 v[122:123], v[122:123], v[18:19], v[60:61] neg_lo:[0,0,1] neg_hi:[0,0,1]
  s_waitcnt lgkmcnt(0)
  v_pk_mul_f32 v[54:55], v[124:125], v[28:29]
  v_pk_mul_f32 v[62:63], v[108:109], v[28:29]
  v_pk_fma_f32 v[108:109], v[108:109], v[24:25], v[54:55]
  v_pk_fma_f32 v[124:125], v[124:125], v[24:25], v[62:63] neg_lo:[0,0,1] neg_hi:[0,0,1]
  v_pk_mul_f32 v[54:55], v[126:127], v[30:31]
  v_pk_mul_f32 v[62:63], v[110:111], v[30:31]
  v_pk_fma_f32 v[110:111], v[110:111], v[26:27], v[54:55]
  v_pk_fma_f32 v[126:127], v[126:127], v[26:27], v[62:63] neg_lo:[0,0,1] neg_hi:[0,0,1]
  v_pk_add_f32 v[16:17], v[64:65], v[96:97]
  v_pk_add_f32 v[18:19], v[66:67], v[98:99]
  v_pk_add_f32 v[20:21], v[64:65], v[96:97] neg_lo:[0,1] neg_hi:[0,1]
  v_pk_add_f32 v[22:23], v[66:67], v[98:99] neg_lo:[0,1] neg_hi:[0,1]
  v_cvt_pk_bf16_f32 v32, v16, v17
  v_cvt_pk_bf16_f32 v33, v18, v19
  v_cvt_pk_bf16_f32 v48, v20, v21
  v_cvt_pk_bf16_f32 v49, v22, v23
  v_pk_add_f32 v[24:25], v[68:69], v[100:101]
  v_pk_add_f32 v[26:27], v[70:71], v[102:103]
  v_pk_add_f32 v[28:29], v[68:69], v[100:101] neg_lo:[0,1] neg_hi:[0,1]
  v_pk_add_f32 v[30:31], v[70:71], v[102:103] neg_lo:[0,1] neg_hi:[0,1]
  v_cvt_pk_bf16_f32 v34, v24, v25
  v_cvt_pk_bf16_f32 v35, v26, v27
  v_cvt_pk_bf16_f32 v50, v28, v29
  v_cvt_pk_bf16_f32 v51, v30, v31
  v_pk_add_f32 v[16:17], v[72:73], v[104:105]
  v_pk_add_f32 v[18:19], v[74:75], v[106:107]
  v_pk_add_f32 v[20:21], v[72:73], v[104:105] neg_lo:[0,1] neg_hi:[0,1]
  v_pk_add_f32 v[22:23], v[74:75], v[106:107] neg_lo:[0,1] neg_hi:[0,1]
  v_cvt_pk_bf16_f32 v36, v16, v17
  v_cvt_pk_bf16_f32 v37, v18, v19
  v_cvt_pk_bf16_f32 v52, v20, v21
  v_cvt_pk_bf16_f32 v53, v22, v23
  v_pk_add_f32 v[24:25], v[76:77], v[108:109]
  v_pk_add_f32 v[26:27], v[78:79], v[110:111]
  v_pk_add_f32 v[28:29], v[76:77], v[108:109] neg_lo:[0,1] neg_hi:[0,1]
  v_pk_add_f32 v[30:31], v[78:79], v[110:111] neg_lo:[0,1] neg_hi:[0,1]
  v_cvt_pk_bf16_f32 v38, v24, v25
  v_cvt_pk_bf16_f32 v39, v26, v27
  v_cvt_pk_bf16_f32 v54, v28, v29
  v_cvt_pk_bf16_f32 v55, v30, v31
  v_pk_add_f32 v[16:17], v[80:81], v[112:113]
  v_pk_add_f32 v[18:19], v[82:83], v[114:115]
  v_pk_add_f32 v[20:21], v[80:81], v[112:113] neg_lo:[0,1] neg_hi:[0,1]
  v_pk_add_f32 v[22:23], v[82:83], v[114:115] neg_lo:[0,1] neg_hi:[0,1]
  v_cvt_pk_bf16_f32 v40, v16, v17
  v_cvt_pk_bf16_f32 v41, v18, v19
  v_cvt_pk_bf16_f32 v56, v20, v21
  v_cvt_pk_bf16_f32 v57, v22, v23
  v_pk_add_f32 v[24:25], v[84:85], v[116:117]
  v_pk_add_f32 v[26:27], v[86:87], v[118:119]
  v_pk_add_f32 v[28:29], v[84:85], v[116:117] neg_lo:[0,1] neg_hi:[0,1]
  v_pk_add_f32 v[30:31], v[86:87], v[118:119] neg_lo:[0,1] neg_hi:[0,1]
  v_cvt_pk_bf16_f32 v42, v24, v25
  v_cvt_pk_bf16_f32 v43, v26, v27
  v_cvt_pk_bf16_f32 v58, v28, v29
  v_cvt_pk_bf16_f32 v59, v30, v31
  v_pk_add_f32 v[16:17], v[88:89], v[120:121]
  v_pk_add_f32 v[18:19], v[90:91], v[122:123]
  v_pk_add_f32 v[20:21], v[88:89], v[120:121] neg_lo:[0,1] neg_hi:[0,1]
  v_pk_add_f32 v[22:23], v[90:91], v[122:123] neg_lo:[0,1] neg_hi:[0,1]
  v_cvt_pk_bf16_f32 v44, v16, v17
  v_cvt_pk_bf16_f32 v45, v18, v19
  v_cvt_pk_bf16_f32 v60, v20, v21
  v_cvt_pk_bf16_f32 v61, v22, v23
  v_pk_add_f32 v[24:25], v[92:93], v[124:125]
  v_pk_add_f32 v[26:27], v[94:95], v[126:127]
  v_pk_add_f32 v[28:29], v[92:93], v[124:125] neg_lo:[0,1] neg_hi:[0,1]
  v_pk_add_f32 v[30:31], v[94:95], v[126:127] neg_lo:[0,1] neg_hi:[0,1]
  v_cvt_pk_bf16_f32 v46, v24, v25
  v_cvt_pk_bf16_f32 v47, v26, v27
  v_cvt_pk_bf16_f32 v62, v28, v29
  v_cvt_pk_bf16_f32 v63, v30, v31
  ds_read_b128 a[120:123], v14 offset:32768
  ds_read_b128 a[124:127], v14 offset:33792
  ds_read_b128 v[16:19], v14 offset:34816
  ds_read_b128 v[20:23], v14 offset:35840
  ds_read_b128 v[24:27], v14 offset:36864
  ds_read_b128 v[28:31], v14 offset:37888
  s_waitcnt lgkmcnt(0)
  v_mfma_f32_32x32x16_bf16 v[64:79], a[120:123], v[32:35], 0
  v_mfma_f32_32x32x16_bf16 v[80:95], a[120:123], v[40:43], 0
  v_mfma_f32_32x32x16_bf16 v[64:79], a[124:127], v[36:39], v[64:79]
  v_mfma_f32_32x32x16_bf16 v[80:95], a[124:127], v[44:47], v[80:95]
  v_mfma_f32_32x32x16_bf16 v[64:79], v[16:19], v[40:43], v[64:79]
  v_mfma_f32_32x32x16_bf16 v[80:95], v[24:27], v[32:35], v[80:95]
  v_mfma_f32_32x32x16_bf16 v[64:79], v[20:23], v[44:47], v[64:79]
  v_mfma_f32_32x32x16_bf16 v[80:95], v[28:31], v[36:39], v[80:95]
  ds_read_b128 a[120:123], v14 offset:38912
  ds_read_b128 a[124:127], v14 offset:39936
  ds_read_b128 v[16:19], v14 offset:40960
  ds_read_b128 v[20:23], v14 offset:41984
  ds_read_b128 v[24:27], v14 offset:43008
  ds_read_b128 v[28:31], v14 offset:44032
  s_waitcnt lgkmcnt(0)
  v_mfma_f32_32x32x16_bf16 v[96:111], a[120:123], v[48:51], 0
  v_mfma_f32_32x32x16_bf16 v[112:127], a[120:123], v[56:59], 0
  v_mfma_f32_32x32x16_bf16 v[96:111], a[124:127], v[52:55], v[96:111]
  v_mfma_f32_32x32x16_bf16 v[112:127], a[124:127], v[60:63], v[112:127]
  v_mfma_f32_32x32x16_bf16 v[96:111], v[16:19], v[56:59], v[96:111]
  v_mfma_f32_32x32x16_bf16 v[112:127], v[24:27], v[48:51], v[112:127]
  v_mfma_f32_32x32x16_bf16 v[96:111], v[20:23], v[60:63], v[96:111]
  v_mfma_f32_32x32x16_bf16 v[112:127], v[28:31], v[52:55], v[112:127]
  s_waitcnt vmcnt(0)
  s_nop 3
  v_accvgpr_read_b32 v20, a88
  v_accvgpr_read_b32 v21, a89
  v_accvgpr_read_b32 v22, a90
  v_accvgpr_read_b32 v23, a91
  v_lshlrev_b32 v16, 16, v20
  v_and_b32 v20, 0xffff0000, v20
  v_lshlrev_b32 v17, 16, v21
  v_and_b32 v21, 0xffff0000, v21
  v_lshlrev_b32 v18, 16, v22
  v_and_b32 v22, 0xffff0000, v22
  v_lshlrev_b32 v19, 16, v23
  v_and_b32 v23, 0xffff0000, v23
  v_pk_mul_f32 v[32:33], v[80:81], v[20:21]
  v_pk_mul_f32 v[40:41], v[64:65], v[20:21]
  v_pk_fma_f32 v[64:65], v[64:65], v[16:17], v[32:33] neg_lo:[0,0,1] neg_hi:[0,0,1]
  v_pk_fma_f32 v[80:81], v[80:81], v[16:17], v[40:41]
  v_pk_mul_f32 v[32:33], v[82:83], v[22:23]
  v_pk_mul_f32 v[40:41], v[66:67], v[22:23]
  v_pk_fma_f32 v[66:67], v[66:67], v[18:19], v[32:33] neg_lo:[0,0,1] neg_hi:[0,0,1]
  v_pk_fma_f32 v[82:83], v[82:83], v[18:19], v[40:41]
  v_cvt_pk_bf16_f32 v32, v64, v65
  v_cvt_pk_bf16_f32 v33, v66, v67
  v_cvt_pk_bf16_f32 v40, v80, v81
  v_cvt_pk_bf16_f32 v41, v82, v83
  v_accvgpr_read_b32 v28, a92
  v_accvgpr_read_b32 v29, a93
  v_accvgpr_read_b32 v30, a94
  v_accvgpr_read_b32 v31, a95
  v_lshlrev_b32 v24, 16, v28
  v_and_b32 v28, 0xffff0000, v28
  v_lshlrev_b32 v25, 16, v29
  v_and_b32 v29, 0xffff0000, v29
  v_lshlrev_b32 v26, 16, v30
  v_and_b32 v30, 0xffff0000, v30
  v_lshlrev_b32 v27, 16, v31
  v_and_b32 v31, 0xffff0000, v31
  v_pk_mul_f32 v[34:35], v[84:85], v[28:29]
  v_pk_mul_f32 v[42:43], v[68:69], v[28:29]
  v_pk_fma_f32 v[68:69], v[68:69], v[24:25], v[34:35] neg_lo:[0,0,1] neg_hi:[0,0,1]
  v_pk_fma_f32 v[84:85], v[84:85], v[24:25], v[42:43]
  v_pk_mul_f32 v[34:35], v[86:87], v[30:31]
  v_pk_mul_f32 v[42:43], v[70:71], v[30:31]
  v_pk_fma_f32 v[70:71], v[70:71], v[26:27], v[34:35] neg_lo:[0,0,1] neg_hi:[0,0,1]
  v_pk_fma_f32 v[86:87], v[86:87], v[26:27], v[42:43]
  v_cvt_pk_bf16_f32 v34, v68, v69
  v_cvt_pk_bf16_f32 v35, v70, v71
  v_cvt_pk_bf16_f32 v42, v84, v85
  v_cvt_pk_bf16_f32 v43, v86, v87
  v_accvgpr_read_b32 v20, a96
  v_accvgpr_read_b32 v21, a97
  v_accvgpr_read_b32 v22, a98
  v_accvgpr_read_b32 v23, a99
  v_lshlrev_b32 v16, 16, v20
  v_and_b32 v20, 0xffff0000, v20
  v_lshlrev_b32 v17, 16, v21
  v_and_b32 v21, 0xffff0000, v21
  v_lshlrev_b32 v18, 16, v22
  v_and_b32 v22, 0xffff0000, v22
  v_lshlrev_b32 v19, 16, v23
  v_and_b32 v23, 0xffff0000, v23
  v_pk_mul_f32 v[36:37], v[88:89], v[20:21]
  v_pk_mul_f32 v[44:45], v[72:73], v[20:21]
  v_pk_fma_f32 v[72:73], v[72:73], v[16:17], v[36:37] neg_lo:[0,0,1] neg_hi:[0,0,1]
  v_pk_fma_f32 v[88:89], v[88:89], v[16:17], v[44:45]
  v_pk_mul_f32 v[36:37], v[90:91], v[22:23]
  v_pk_mul_f32 v[44:45], v[74:75], v[22:23]
  v_pk_fma_f32 v[74:75], v[74:75], v[18:19], v[36:37] neg_lo:[0,0,1] neg_hi:[0,0,1]
  v_pk_fma_f32 v[90:91], v[90:91], v[18:19], v[44:45]
  v_cvt_pk_bf16_f32 v36, v72, v73
  v_cvt_pk_bf16_f32 v37, v74, v75
  v_cvt_pk_bf16_f32 v44, v88, v89
  v_cvt_pk_bf16_f32 v45, v90, v91
  v_accvgpr_read_b32 v28, a100
  v_accvgpr_read_b32 v29, a101
  v_accvgpr_read_b32 v30, a102
  v_accvgpr_read_b32 v31, a103
  v_lshlrev_b32 v24, 16, v28
  v_and_b32 v28, 0xffff0000, v28
  v_lshlrev_b32 v25, 16, v29
  v_and_b32 v29, 0xffff0000, v29
  v_lshlrev_b32 v26, 16, v30
  v_and_b32 v30, 0xffff0000, v30
  v_lshlrev_b32 v27, 16, v31
  v_and_b32 v31, 0xffff0000, v31
  v_pk_mul_f32 v[38:39], v[92:93], v[28:29]
  v_pk_mul_f32 v[46:47], v[76:77], v[28:29]
  v_pk_fma_f32 v[76:77], v[76:77], v[24:25], v[38:39] neg_lo:[0,0,1] neg_hi:[0,0,1]
  v_pk_fma_f32 v[92:93], v[92:93], v[24:25], v[46:47]
  v_pk_mul_f32 v[38:39], v[94:95], v[30:31]
  v_pk_mul_f32 v[46:47], v[78:79], v[30:31]
  v_pk_fma_f32 v[78:79], v[78:79], v[26:27], v[38:39] neg_lo:[0,0,1] neg_hi:[0,0,1]
  v_pk_fma_f32 v[94:95], v[94:95], v[26:27], v[46:47]
  v_cvt_pk_bf16_f32 v38, v76, v77
  v_cvt_pk_bf16_f32 v39, v78, v79
  v_cvt_pk_bf16_f32 v46, v92, v93
  v_cvt_pk_bf16_f32 v47, v94, v95
  v_accvgpr_read_b32 v20, a104
  v_accvgpr_read_b32 v21, a105
  v_accvgpr_read_b32 v22, a106
  v_accvgpr_read_b32 v23, a107
  v_lshlrev_b32 v16, 16, v20
  v_and_b32 v20, 0xffff0000, v20
  v_lshlrev_b32 v17, 16, v21
  v_and_b32 v21, 0xffff0000, v21
  v_lshlrev_b32 v18, 16, v22
  v_and_b32 v22, 0xffff0000, v22
  v_lshlrev_b32 v19, 16, v23
  v_and_b32 v23, 0xffff0000, v23
  s_nop 3
  v_pk_mul_f32 v[48:49], v[112:113], v[20:21]
  v_pk_mul_f32 v[56:57], v[96:97], v[20:21]
  v_pk_fma_f32 v[96:97], v[96:97], v[16:17], v[48:49] neg_lo:[0,0,1] neg_hi:[0,0,1]
  v_pk_fma_f32 v[112:113], v[112:113], v[16:17], v[56:57]
  v_pk_mul_f32 v[48:49], v[114:115], v[22:23]
  v_pk_mul_f32 v[56:57], v[98:99], v[22:23]
  v_pk_fma_f32 v[98:99], v[98:99], v[18:19], v[48:49] neg_lo:[0,0,1] neg_hi:[0,0,1]
  v_pk_fma_f32 v[114:115], v[114:115], v[18:19], v[56:57]
  v_cvt_pk_bf16_f32 v48, v96, v97
  v_cvt_pk_bf16_f32 v49, v98, v99
  v_cvt_pk_bf16_f32 v56, v112, v113
  v_cvt_pk_bf16_f32 v57, v114, v115
  v_accvgpr_read_b32 v28, a108
  v_accvgpr_read_b32 v29, a109
  v_accvgpr_read_b32 v30, a110
  v_accvgpr_read_b32 v31, a111
  v_lshlrev_b32 v24, 16, v28
  v_and_b32 v28, 0xffff0000, v28
  v_lshlrev_b32 v25, 16, v29
  v_and_b32 v29, 0xffff0000, v29
  v_lshlrev_b32 v26, 16, v30
  v_and_b32 v30, 0xffff0000, v30
  v_lshlrev_b32 v27, 16, v31
  v_and_b32 v31, 0xffff0000, v31
  v_pk_mul_f32 v[50:51], v[116:117], v[28:29]
  v_pk_mul_f32 v[58:59], v[100:101], v[28:29]
  v_pk_fma_f32 v[100:101], v[100:101], v[24:25], v[50:51] neg_lo:[0,0,1] neg_hi:[0,0,1]
  v_pk_fma_f32 v[116:117], v[116:117], v[24:25], v[58:59]
  v_pk_mul_f32 v[50:51], v[118:119], v[30:31]
  v_pk_mul_f32 v[58:59], v[102:103], v[30:31]
  v_pk_fma_f32 v[102:103], v[102:103], v[26:27], v[50:51] neg_lo:[0,0,1] neg_hi:[0,0,1]
  v_pk_fma_f32 v[118:119], v[118:119], v[26:27], v[58:59]
  v_cvt_pk_bf16_f32 v50, v100, v101
  v_cvt_pk_bf16_f32 v51, v102, v103
  v_cvt_pk_bf16_f32 v58, v116, v117
  v_cvt_pk_bf16_f32 v59, v118, v119
  v_accvgpr_read_b32 v20, a112
  v_accvgpr_read_b32 v21, a113
  v_accvgpr_read_b32 v22, a114
  v_accvgpr_read_b32 v23, a115
  v_lshlrev_b32 v16, 16, v20
  v_and_b32 v20, 0xffff0000, v20
  v_lshlrev_b32 v17, 16, v21
  v_and_b32 v21, 0xffff0000, v21
  v_lshlrev_b32 v18, 16, v22
  v_and_b32 v22, 0xffff0000, v22
  v_lshlrev_b32 v19, 16, v23
  v_and_b32 v23, 0xffff0000, v23
  v_pk_mul_f32 v[52:53], v[120:121], v[20:21]
  v_pk_mul_f32 v[60:61], v[104:105], v[20:21]
  v_pk_fma_f32 v[104:105], v[104:105], v[16:17], v[52:53] neg_lo:[0,0,1] neg_hi:[0,0,1]
  v_pk_fma_f32 v[120:121], v[120:121], v[16:17], v[60:61]
  v_pk_mul_f32 v[52:53], v[122:123], v[22:23]
  v_pk_mul_f32 v[60:61], v[106:107], v[22:23]
  v_pk_fma_f32 v[106:107], v[106:107], v[18:19], v[52:53] neg_lo:[0,0,1] neg_hi:[0,0,1]
  v_pk_fma_f32 v[122:123], v[122:123], v[18:19], v[60:61]
  v_cvt_pk_bf16_f32 v52, v104, v105
  v_cvt_pk_bf16_f32 v53, v106, v107
  v_cvt_pk_bf16_f32 v60, v120, v121
  v_cvt_pk_bf16_f32 v61, v122, v123
  v_accvgpr_read_b32 v28, a116
  v_accvgpr_read_b32 v29, a117
  v_accvgpr_read_b32 v30, a118
  v_accvgpr_read_b32 v31, a119
  v_lshlrev_b32 v24, 16, v28
  v_and_b32 v28, 0xffff0000, v28
  v_lshlrev_b32 v25, 16, v29
  v_and_b32 v29, 0xffff0000, v29
  v_lshlrev_b32 v26, 16, v30
  v_and_b32 v30, 0xffff0000, v30
  v_lshlrev_b32 v27, 16, v31
  v_and_b32 v31, 0xffff0000, v31
  v_pk_mul_f32 v[54:55], v[124:125], v[28:29]
  v_pk_mul_f32 v[62:63], v[108:109], v[28:29]
  v_pk_fma_f32 v[108:109], v[108:109], v[24:25], v[54:55] neg_lo:[0,0,1] neg_hi:[0,0,1]
  v_pk_fma_f32 v[124:125], v[124:125], v[24:25], v[62:63]
  v_pk_mul_f32 v[54:55], v[126:127], v[30:31]
  v_pk_mul_f32 v[62:63], v[110:111], v[30:31]
  v_pk_fma_f32 v[110:111], v[110:111], v[26:27], v[54:55] neg_lo:[0,0,1] neg_hi:[0,0,1]
  v_pk_fma_f32 v[126:127], v[126:127], v[26:27], v[62:63]
  v_cvt_pk_bf16_f32 v54, v108, v109
  v_cvt_pk_bf16_f32 v55, v110, v111
  v_cvt_pk_bf16_f32 v62, v124, v125
  v_cvt_pk_bf16_f32 v63, v126, v127
  ds_read_b128 a[120:123], v14 offset:32768
  ds_read_b128 a[124:127], v14 offset:33792
  ds_read_b128 v[16:19], v14 offset:34816
  ds_read_b128 v[20:23], v14 offset:35840
  ds_read_b128 v[24:27], v14 offset:36864
  ds_read_b128 v[28:31], v14 offset:37888
  s_waitcnt lgkmcnt(0)
  v_mfma_f32_32x32x16_bf16 v[64:79], v[32:35], a[120:123], 0
  v_mfma_f32_32x32x16_bf16 v[80:95], v[40:43], a[120:123], 0
  v_mfma_f32_32x32x16_bf16 v[64:79], v[36:39], a[124:127], v[64:79]
  v_mfma_f32_32x32x16_bf16 v[80:95], v[44:47], a[124:127], v[80:95]
  v_mfma_f32_32x32x16_bf16 v[64:79], v[40:43], v[24:27], v[64:79]
  v_mfma_f32_32x32x16_bf16 v[80:95], v[32:35], v[16:19], v[80:95]
  v_mfma_f32_32x32x16_bf16 v[64:79], v[44:47], v[28:31], v[64:79]
  v_mfma_f32_32x32x16_bf16 v[80:95], v[36:39], v[20:23], v[80:95]
  ds_read_b128 a[120:123], v14 offset:45056
  ds_read_b128 a[124:127], v14 offset:46080
  ds_read_b128 v[16:19], v14 offset:47104
  ds_read_b128 v[20:23], v14 offset:48128
  ds_read_b128 v[24:27], v14 offset:49152
  ds_read_b128 v[28:31], v14 offset:50176
  s_waitcnt lgkmcnt(0)
  v_mfma_f32_32x32x16_bf16 v[96:111], v[48:51], a[120:123], 0
  v_mfma_f32_32x32x16_bf16 v[112:127], v[56:59], a[120:123], 0
  v_mfma_f32_32x32x16_bf16 v[96:111], v[52:55], a[124:127], v[96:111]
  v_mfma_f32_32x32x16_bf16 v[112:127], v[60:63], a[124:127], v[112:127]
  v_mfma_f32_32x32x16_bf16 v[96:111], v[56:59], v[24:27], v[96:111]
  v_mfma_f32_32x32x16_bf16 v[112:127], v[48:51], v[16:19], v[112:127]
  v_mfma_f32_32x32x16_bf16 v[96:111], v[60:63], v[28:31], v[96:111]
  v_mfma_f32_32x32x16_bf16 v[112:127], v[52:55], v[20:23], v[112:127]
  s_nop 15
  v_pk_add_f32 v[16:17], v[64:65], v[96:97]
  v_pk_add_f32 v[96:97], v[64:65], v[96:97] neg_lo:[0,1] neg_hi:[0,1]
  v_mov_b32 v64, v16
  v_mov_b32 v65, v17
  v_pk_add_f32 v[18:19], v[66:67], v[98:99]
  v_pk_add_f32 v[98:99], v[66:67], v[98:99] neg_lo:[0,1] neg_hi:[0,1]
  v_mov_b32 v66, v18
  v_mov_b32 v67, v19
  v_pk_add_f32 v[20:21], v[68:69], v[100:101]
  v_pk_add_f32 v[100:101], v[68:69], v[100:101] neg_lo:[0,1] neg_hi:[0,1]
  v_mov_b32 v68, v20
  v_mov_b32 v69, v21
  v_pk_add_f32 v[22:23], v[70:71], v[102:103]
  v_pk_add_f32 v[102:103], v[70:71], v[102:103] neg_lo:[0,1] neg_hi:[0,1]
  v_mov_b32 v70, v22
  v_mov_b32 v71, v23
  v_pk_add_f32 v[16:17], v[72:73], v[104:105]
  v_pk_add_f32 v[104:105], v[72:73], v[104:105] neg_lo:[0,1] neg_hi:[0,1]
  v_mov_b32 v72, v16
  v_mov_b32 v73, v17
  v_pk_add_f32 v[18:19], v[74:75], v[106:107]
  v_pk_add_f32 v[106:107], v[74:75], v[106:107] neg_lo:[0,1] neg_hi:[0,1]
  v_mov_b32 v74, v18
  v_mov_b32 v75, v19
  v_pk_add_f32 v[20:21], v[76:77], v[108:109]
  v_pk_add_f32 v[108:109], v[76:77], v[108:109] neg_lo:[0,1] neg_hi:[0,1]
  v_mov_b32 v76, v20
  v_mov_b32 v77, v21
  v_pk_add_f32 v[22:23], v[78:79], v[110:111]
  v_pk_add_f32 v[110:111], v[78:79], v[110:111] neg_lo:[0,1] neg_hi:[0,1]
  v_mov_b32 v78, v22
  v_mov_b32 v79, v23
  v_pk_add_f32 v[16:17], v[80:81], v[112:113]
  v_pk_add_f32 v[112:113], v[80:81], v[112:113] neg_lo:[0,1] neg_hi:[0,1]
  v_mov_b32 v80, v16
  v_mov_b32 v81, v17
  v_pk_add_f32 v[18:19], v[82:83], v[114:115]
  v_pk_add_f32 v[114:115], v[82:83], v[114:115] neg_lo:[0,1] neg_hi:[0,1]
  v_mov_b32 v82, v18
  v_mov_b32 v83, v19
  v_pk_add_f32 v[20:21], v[84:85], v[116:117]
  v_pk_add_f32 v[116:117], v[84:85], v[116:117] neg_lo:[0,1] neg_hi:[0,1]
  v_mov_b32 v84, v20
  v_mov_b32 v85, v21
  v_pk_add_f32 v[22:23], v[86:87], v[118:119]
  v_pk_add_f32 v[118:119], v[86:87], v[118:119] neg_lo:[0,1] neg_hi:[0,1]
  v_mov_b32 v86, v22
  v_mov_b32 v87, v23
  v_pk_add_f32 v[16:17], v[88:89], v[120:121]
  v_pk_add_f32 v[120:121], v[88:89], v[120:121] neg_lo:[0,1] neg_hi:[0,1]
  v_mov_b32 v88, v16
  v_mov_b32 v89, v17
  v_pk_add_f32 v[18:19], v[90:91], v[122:123]
  v_pk_add_f32 v[122:123], v[90:91], v[122:123] neg_lo:[0,1] neg_hi:[0,1]
  v_mov_b32 v90, v18
  v_mov_b32 v91, v19
  v_pk_add_f32 v[20:21], v[92:93], v[124:125]
  v_pk_add_f32 v[124:125], v[92:93], v[124:125] neg_lo:[0,1] neg_hi:[0,1]
  v_mov_b32 v92, v20
  v_mov_b32 v93, v21
  v_pk_add_f32 v[22:23], v[94:95], v[126:127]
  v_pk_add_f32 v[126:127], v[94:95], v[126:127] neg_lo:[0,1] neg_hi:[0,1]
  v_mov_b32 v94, v22
  v_mov_b32 v95, v23
  ds_read_b128 v[16:19], v14 offset:16384
  ds_read_b128 v[20:23], v14 offset:17408
  ds_read_b128 v[24:27], v14 offset:18432
  ds_read_b128 v[28:31], v14 offset:19456
  s_waitcnt lgkmcnt(2)
  v_pk_mul_f32 v[32:33], v[80:81], v[20:21]
  v_pk_mul_f32 v[40:41], v[64:65], v[20:21]
  v_pk_fma_f32 v[64:65], v[64:65], v[16:17], v[32:33] neg_lo:[0,0,1] neg_hi:[0,0,1]
  v_pk_fma_f32 v[80:81], v[80:81], v[16:17], v[40:41]
  v_pk_mul_f32 v[32:33], v[82:83], v[22:23]
  v_pk_mul_f32 v[40:41], v[66:67], v[22:23]
  v_pk_fma_f32 v[66:67], v[66:67], v[18:19], v[32:33] neg_lo:[0,0,1] neg_hi:[0,0,1]
  v_pk_fma_f32 v[82:83], v[82:83], v[18:19], v[40:41]
  v_cvt_pk_bf16_f32 v32, v64, v65
  v_cvt_pk_bf16_f32 v33, v66, v67
  v_cvt_pk_bf16_f32 v40, v80, v81
  v_cvt_pk_bf16_f32 v41, v82, v83
  ds_read_b128 v[16:19], v14 offset:20480
  ds_read_b128 v[20:23], v14 offset:21504
  s_waitcnt lgkmcnt(2)
  v_pk_mul_f32 v[34:35], v[84:85], v[28:29]
  v_pk_mul_f32 v[42:43], v[68:69], v[28:29]
  v_pk_fma_f32 v[68:69], v[68:69], v[24:25], v[34:35] neg_lo:[0,0,1] neg_hi:[0,0,1]
  v_pk_fma_f32 v[84:85], v[84:85], v[24:25], v[42:43]
  v_pk_mul_f32 v[34:35], v[86:87], v[30:31]
  v_pk_mul_f32 v[42:43], v[70:71], v[30:31]
  v_pk_fma_f32 v[70:71], v[70:71], v[26:27], v[34:35] neg_lo:[0,0,1] neg_hi:[0,0,1]
  v_pk_fma_f32 v[86:87], v[86:87], v[26:27], v[42:43]
  v_cvt_pk_bf16_f32 v34, v68, v69
  v_cvt_pk_bf16_f32 v35, v70, v71
  v_cvt_pk_bf16_f32 v42, v84, v85
  v_cvt_pk_bf16_f32 v43, v86, v87
  ds_read_b128 v[24:27], v14 offset:22528
  ds_read_b128 v[28:31], v14 offset:23552
  s_waitcnt lgkmcnt(2)
  v_pk_mul_f32 v[36:37], v[88:89], v[20:21]
  v_pk_mul_f32 v[44:45], v[72:73], v[20:21]
  v_pk_fma_f32 v[72:73], v[72:73], v[16:17], v[36:37] neg_lo:[0,0,1] neg_hi:[0,0,1]
  v_pk_fma_f32 v[88:89], v[88:89], v[16:17], v[44:45]
  v_pk_mul_f32 v[36:37], v[90:91], v[22:23]
  v_pk_mul_f32 v[44:45], v[74:75], v[22:23]
  v_pk_fma_f32 v[74:75], v[74:75], v[18:19], v[36:37] neg_lo:[0,0,1] neg_hi:[0,0,1]
  v_pk_fma_f32 v[90:91], v[90:91], v[18:19], v[44:45]
  v_cvt_pk_bf16_f32 v36, v72, v73
  v_cvt_pk_bf16_f32 v37, v74, v75
  v_cvt_pk_bf16_f32 v44, v88, v89
  v_cvt_pk_bf16_f32 v45, v90, v91
  ds_read_b128 v[16:19], v14 offset:24576
  ds_read_b128 v[20:23], v14 offset:25600
  s_waitcnt lgkmcnt(2)
  v_pk_mul_f32 v[38:39], v[92:93], v[28:29]
  v_pk_mul_f32 v[46:47], v[76:77], v[28:29]
  v_pk_fma_f32 v[76:77], v[76:77], v[24:25], v[38:39] neg_lo:[0,0,1] neg_hi:[0,0,1]
  v_pk_fma_f32 v[92:93], v[92:93], v[24:25], v[46:47]
  v_pk_mul_f32 v[38:39], v[94:95], v[30:31]
  v_pk_mul_f32 v[46:47], v[78:79], v[30:31]
  v_pk_fma_f32 v[78:79], v[78:79], v[26:27], v[38:39] neg_lo:[0,0,1] neg_hi:[0,0,1]
  v_pk_fma_f32 v[94:95], v[94:95], v[26:27], v[46:47]
  v_cvt_pk_bf16_f32 v38, v76, v77
  v_cvt_pk_bf16_f32 v39, v78, v79
  v_cvt_pk_bf16_f32 v46, v92, v93
  v_cvt_pk_bf16_f32 v47, v94, v95
  ds_read_b128 v[24:27], v14 offset:26624
  ds_read_b128 v[28:31], v14 offset:27648
  s_waitcnt lgkmcnt(2)
  v_pk_mul_f32 v[48:49], v[112:113], v[20:21]
  v_pk_mul_f32 v[56:57], v[96:97], v[20:21]
  v_pk_fma_f32 v[96:97], v[96:97], v[16:17], v[48:49] neg_lo:[0,0,1] neg_hi:[0,0,1]
  v_pk_fma_f32 v[112:113], v[112:113], v[16:17], v[56:57]
  v_pk_mul_f32 v[48:49], v[114:115], v[22:23]
  v_pk_mul_f32 v[56:57], v[98:99], v[22:23]
  v_pk_fma_f32 v[98:99], v[98:99], v[18:19], v[48:49] neg_lo:[0,0,1] neg_hi:[0,0,1]
  v_pk_fma_f32 v[114:115], v[114:115], v[18:19], v[56:57]
  v_cvt_pk_bf16_f32 v48, v96, v97
  v_cvt_pk_bf16_f32 v49, v98, v99
  v_cvt_pk_bf16_f32 v56, v112, v113
  v_cvt_pk_bf16_f32 v57, v114, v115
  ds_read_b128 v[16:19], v14 offset:28672
  ds_read_b128 v[20:23], v14 offset:29696
  s_waitcnt lgkmcnt(2)
  v_pk_mul_f32 v[50:51], v[116:117], v[28:29]
  v_pk_mul_f32 v[58:59], v[100:101], v[28:29]
  v_pk_fma_f32 v[100:101], v[100:101], v[24:25], v[50:51] neg_lo:[0,0,1] neg_hi:[0,0,1]
  v_pk_fma_f32 v[116:117], v[116:117], v[24:25], v[58:59]
  v_pk_mul_f32 v[50:51], v[118:119], v[30:31]
  v_pk_mul_f32 v[58:59], v[102:103], v[30:31]
  v_pk_fma_f32 v[102:103], v[102:103], v[26:27], v[50:51] neg_lo:[0,0,1] neg_hi:[0,0,1]
  v_pk_fma_f32 v[118:119], v[118:119], v[26:27], v[58:59]
  v_cvt_pk_bf16_f32 v50, v100, v101
  v_cvt_pk_bf16_f32 v51, v102, v103
  v_cvt_pk_bf16_f32 v58, v116, v117
  v_cvt_pk_bf16_f32 v59, v118, v119
  ds_read_b128 v[24:27], v14 offset:30720
  ds_read_b128 v[28:31], v14 offset:31744
  s_waitcnt lgkmcnt(2)
  v_pk_mul_f32 v[52:53], v[120:121], v[20:21]
  v_pk_mul_f32 v[60:61], v[104:105], v[20:21]
  v_pk_fma_f32 v[104:105], v[104:105], v[16:17], v[52:53] neg_lo:[0,0,1] neg_hi:[0,0,1]
  v_pk_fma_f32 v[120:121], v[120:121], v[16:17], v[60:61]
  v_pk_mul_f32 v[52:53], v[122:123], v[22:23]
  v_pk_mul_f32 v[60:61], v[106:107], v[22:23]
  v_pk_fma_f32 v[106:107], v[106:107], v[18:19], v[52:53] neg_lo:[0,0,1] neg_hi:[0,0,1]
  v_pk_fma_f32 v[122:123], v[122:123], v[18:19], v[60:61]
  v_cvt_pk_bf16_f32 v52, v104, v105
  v_cvt_pk_bf16_f32 v53, v106, v107
  v_cvt_pk_bf16_f32 v60, v120, v121
  v_cvt_pk_bf16_f32 v61, v122, v123
  s_waitcnt lgkmcnt(0)
  v_pk_mul_f32 v[54:55], v[124:125], v[28:29]
  v_pk_mul_f32 v[62:63], v[108:109], v[28:29]
  v_pk_fma_f32 v[108:109], v[108:109], v[24:25], v[54:55] neg_lo:[0,0,1] neg_hi:[0,0,1]
  v_pk_fma_f32 v[124:125], v[124:125], v[24:25], v[62:63]
  v_pk_mul_f32 v[54:55], v[126:127], v[30:31]
  v_pk_mul_f32 v[62:63], v[110:111], v[30:31]
  v_pk_fma_f32 v[110:111], v[110:111], v[26:27], v[54:55] neg_lo:[0,0,1] neg_hi:[0,0,1]
  v_pk_fma_f32 v[126:127], v[126:127], v[26:27], v[62:63]
  v_cvt_pk_bf16_f32 v54, v108, v109
  v_cvt_pk_bf16_f32 v55, v110, v111
  v_cvt_pk_bf16_f32 v62, v124, v125
  v_cvt_pk_bf16_f32 v63, v126, v127
  ds_read_b128 a[120:123], v14 offset:32768
  ds_read_b128 a[124:127], v14 offset:33792
  ds_read_b128 v[16:19], v14 offset:34816
  ds_read_b128 v[20:23], v14 offset:35840
  ds_read_b128 v[24:27], v14 offset:36864
  ds_read_b128 v[28:31], v14 offset:37888
  s_waitcnt lgkmcnt(0)
  v_mfma_f32_32x32x16_bf16 v[64:79], v[32:35], a[120:123], 0
  v_mfma_f32_32x32x16_bf16 v[80:95], v[40:43], a[120:123], 0
  v_mfma_f32_32x32x16_bf16 v[64:79], v[36:39], a[124:127], v[64:79]
  v_mfma_f32_32x32x16_bf16 v[80:95], v[44:47], a[124:127], v[80:95]
  v_mfma_f32_32x32x16_bf16 v[64:79], v[40:43], v[24:27], v[64:79]
  v_mfma_f32_32x32x16_bf16 v[80:95], v[32:35], v[16:19], v[80:95]
  v_mfma_f32_32x32x16_bf16 v[64:79], v[44:47], v[28:31], v[64:79]
  v_mfma_f32_32x32x16_bf16 v[80:95], v[36:39], v[20:23], v[80:95]
  v_mfma_f32_32x32x16_bf16 v[96:111], v[48:51], a[120:123], 0
  v_mfma_f32_32x32x16_bf16 v[112:127], v[56:59], a[120:123], 0
  v_mfma_f32_32x32x16_bf16 v[96:111], v[52:55], a[124:127], v[96:111]
  v_mfma_f32_32x32x16_bf16 v[112:127], v[60:63], a[124:127], v[112:127]
  v_mfma_f32_32x32x16_bf16 v[96:111], v[56:59], v[24:27], v[96:111]
  v_mfma_f32_32x32x16_bf16 v[112:127], v[48:51], v[16:19], v[112:127]
  v_mfma_f32_32x32x16_bf16 v[96:111], v[60:63], v[28:31], v[96:111]
  v_mfma_f32_32x32x16_bf16 v[112:127], v[52:55], v[20:23], v[112:127]
  s_nop 7
  v_lshlrev_b32 v11, 7, v4
  v_lshl_add_u32 v11, v5, 4, v11
  s_lshl_b32 s59, s56, 12
  s_add_u32 s59, s59, 9437184
  v_cvt_pk_bf16_f32 v32, v64, v65
  v_cvt_pk_bf16_f32 v33, v66, v67
  v_cvt_pk_bf16_f32 v34, v68, v69
  v_cvt_pk_bf16_f32 v35, v70, v71
  v_cvt_pk_bf16_f32 v36, v72, v73
  v_cvt_pk_bf16_f32 v37, v74, v75
  v_cvt_pk_bf16_f32 v38, v76, v77
  v_cvt_pk_bf16_f32 v39, v78, v79
  s_nop 1
  v_permlane32_swap_b32 v32, v34
  v_permlane32_swap_b32 v33, v35
  v_permlane32_swap_b32 v36, v38
  v_permlane32_swap_b32 v37, v39
  buffer_store_dwordx4 v[32:35], v11, s[8:11], s59 offen offset:0 sc1
  buffer_store_dwordx4 v[36:39], v11, s[8:11], s59 offen offset:32 sc1
  s_nop 7
  v_cvt_pk_bf16_f32 v48, v96, v97
  v_cvt_pk_bf16_f32 v49, v98, v99
  v_cvt_pk_bf16_f32 v50, v100, v101
  v_cvt_pk_bf16_f32 v51, v102, v103
  v_cvt_pk_bf16_f32 v52, v104, v105
  v_cvt_pk_bf16_f32 v53, v106, v107
  v_cvt_pk_bf16_f32 v54, v108, v109
  v_cvt_pk_bf16_f32 v55, v110, v111
  s_nop 1
  v_permlane32_swap_b32 v48, v50
  v_permlane32_swap_b32 v49, v51
  v_permlane32_swap_b32 v52, v54
  v_permlane32_swap_b32 v53, v55
  buffer_store_dwordx4 v[48:51], v11, s[8:11], s59 offen offset:64 sc1
  buffer_store_dwordx4 v[52:55], v11, s[8:11], s59 offen offset:96 sc1
  s_cmp_eq_u32 s58, 1
  s_cbranch_scc1 ss_117_skip
  s_lshl_b32 s59, s57, 12
  s_add_u32 s59, s59, 9437184
  v_cvt_pk_bf16_f32 v40, v80, v81
  v_cvt_pk_bf16_f32 v41, v82, v83
  v_cvt_pk_bf16_f32 v42, v84, v85
  v_cvt_pk_bf16_f32 v43, v86, v87
  v_cvt_pk_bf16_f32 v44, v88, v89
  v_cvt_pk_bf16_f32 v45, v90, v91
  v_cvt_pk_bf16_f32 v46, v92, v93
  v_cvt_pk_bf16_f32 v47, v94, v95
  s_nop 1
  v_permlane32_swap_b32 v40, v42
  v_permlane32_swap_b32 v41, v43
  v_permlane32_swap_b32 v44, v46
  v_permlane32_swap_b32 v45, v47
  buffer_store_dwordx4 v[40:43], v11, s[8:11], s59 offen offset:0 sc1
  buffer_store_dwordx4 v[44:47], v11, s[8:11], s59 offen offset:32 sc1
  v_cvt_pk_bf16_f32 v56, v112, v113
  v_cvt_pk_bf16_f32 v57, v114, v115
  v_cvt_pk_bf16_f32 v58, v116, v117
  v_cvt_pk_bf16_f32 v59, v118, v119
  v_cvt_pk_bf16_f32 v60, v120, v121
  v_cvt_pk_bf16_f32 v61, v122, v123
  v_cvt_pk_bf16_f32 v62, v124, v125
  v_cvt_pk_bf16_f32 v63, v126, v127
  s_nop 1
  v_permlane32_swap_b32 v56, v58
  v_permlane32_swap_b32 v57, v59
  v_permlane32_swap_b32 v60, v62
  v_permlane32_swap_b32 v61, v63
  buffer_store_dwordx4 v[56:59], v11, s[8:11], s59 offen offset:64 sc1
  buffer_store_dwordx4 v[60:63], v11, s[8:11], s59 offen offset:96 sc1
ss_117_skip:
  s_waitcnt vmcnt(0)
  s_lshl_b32 s86, s69, 6
  s_add_u32 s86, s86, 18087936
  v_mov_b32 v15, s50
  s_mov_b64 s[88:89], exec
  s_mov_b64 exec, 1
  buffer_store_dword v15, off, s[8:11], s86 sc1
  s_mov_b64 exec, s[88:89]
  v_mov_b32 v11, 162828
  v_mov_b32 v12, 1
  s_mov_b64 s[58:59], exec
  s_mov_b64 exec, 1
  ds_add_u32 v11, v12
  s_mov_b64 exec, s[58:59]
  s_waitcnt vmcnt(0) lgkmcnt(0)
  s_sub_u32 s68, s68, 100
  v_lshlrev_b32 v60, 4, v1
  v_lshlrev_b32 v61, 3, v1
  v_min_u32 v62, 20, v4
  v_mad_u32_u24 v62, v5, 21, v62
  v_lshlrev_b32 v62, 4, v62
  s_lshl_b32 s56, s3, 2
  s_xor_b32 s57, s56, 16
  s_add_u32 s56, s56, 162832
  s_add_u32 s57, s57, 162832
  v_mov_b32 v8, s56
  v_mov_b32 v9, s57
  v_mov_b32 v63, 0
  s_sub_u32 s75, s64, 4
  s_lshr_b32 s75, s75, 1
  s_cmp_eq_u32 s75, 0
  s_cbranch_scc1 attn_104
  s_add_u32 s58, s65, 4
  s_cmp_ge_u32 s58, s64
  s_cselect_b32 s59, s64, 0
  s_sub_u32 s58, s58, s59
  s_mul_i32 s72, s58, 2880
  s_add_u32 s72, s72, s74
  buffer_load_dwordx4 v[64:67], v60, s[8:11], s72 offen sc1
  buffer_load_dwordx2 v[76:77], v61, s[8:11], s72 offen offset:1024 sc1
  buffer_load_dwordx4 v[68:71], v62, s[8:11], s72 offen offset:1536 sc1
  buffer_load_dwordx4 v[72:75], v62, s[8:11], s72 offen offset:2208 sc1
  s_add_u32 s72, s72, 2880
  s_cmp_ge_u32 s72, s73
  s_cselect_b32 s72, s74, s72
  buffer_load_dwordx4 v[80:83], v60, s[8:11], s72 offen sc1
  buffer_load_dwordx2 v[92:93], v61, s[8:11], s72 offen offset:1024 sc1
  buffer_load_dwordx4 v[84:87], v62, s[8:11], s72 offen offset:1536 sc1
  buffer_load_dwordx4 v[88:91], v62, s[8:11], s72 offen offset:2208 sc1
  s_add_u32 s72, s72, 2880
  s_cmp_ge_u32 s72, s73
  s_cselect_b32 s72, s74, s72
  buffer_load_dwordx4 v[96:99], v60, s[8:11], s72 offen sc1
  buffer_load_dwordx2 v[108:109], v61, s[8:11], s72 offen offset:1024 sc1
  buffer_load_dwordx4 v[100:103], v62, s[8:11], s72 offen offset:1536 sc1
  buffer_load_dwordx4 v[104:107], v62, s[8:11], s72 offen offset:2208 sc1
  s_add_u32 s72, s72, 2880
  s_cmp_ge_u32 s72, s73
  s_cselect_b32 s72, s74, s72
  s_branch attn_103
attn_104:
  s_setprio 0
  s_cmp_le_u32 s2, 64
  s_cselect_b32 s60, 2, 1
  v_mov_b32 v60, 162828
  s_mov_b32 s88, 0
sp_119:
  ds_read_b32 v61, v60
  s_waitcnt lgkmcnt(0)
  v_readfirstlane_b32 s89, v61
  s_cmp_ge_u32 s89, s60
  s_cbranch_scc1 sp_120
  s_add_u32 s88, s88, 1
  s_cmp_ge_u32 s88, 0x100000
  s_cbranch_scc1 sp_120
  s_sleep 1
  s_branch sp_119
sp_120:
  s_and_b32 s76, s3, 1
  s_lshr_b32 s77, s3, 1
  v_lshlrev_b32 v16, 4, v1
  s_nop 5
  s_cmp_eq_u32 s77, 0
  s_cbranch_scc1 epw_121
  s_sub_u32 s78, s77, 1
  s_and_b32 s78, s78, 3
  s_lshl_b32 s79, s76, 2
  s_add_u32 s79, s79, 0
  s_mul_i32 s79, s79, 3
  s_add_u32 s79, s79, s78
  s_mul_i32 s79, s79, 3072
  s_add_u32 s79, s79, 0
  v_add_u32 v17, s79, v16
  ds_write_b128 v17, a[0:3] offset:0
  ds_write_b128 v17, a[4:7] offset:1024
  ds_write_b128 v17, a[8:11] offset:2048
epw_121:
  s_cmp_eq_u32 s77, 1
  s_cbranch_scc1 epw_122
  s_sub_u32 s78, s77, 2
  s_and_b32 s78, s78, 3
  s_lshl_b32 s79, s76, 2
  s_add_u32 s79, s79, 1
  s_mul_i32 s79, s79, 3
  s_add_u32 s79, s79, s78
  s_mul_i32 s79, s79, 3072
  s_add_u32 s79, s79, 0
  v_add_u32 v17, s79, v16
  ds_write_b128 v17, a[16:19] offset:0
  ds_write_b128 v17, a[20:23] offset:1024
  ds_write_b128 v17, a[24:27] offset:2048
epw_122:
  s_cmp_eq_u32 s77, 2
  s_cbranch_scc1 epw_123
  s_sub_u32 s78, s77, 3
  s_and_b32 s78, s78, 3
  s_lshl_b32 s79, s76, 2
  s_add_u32 s79, s79, 2
  s_mul_i32 s79, s79, 3
  s_add_u32 s79, s79, s78
  s_mul_i32 s79, s79, 3072
  s_add_u32 s79, s79, 0
  v_add_u32 v17, s79, v16
  ds_write_b128 v17, a[32:35] offset:0
  ds_write_b128 v17, a[36:39] offset:1024
  ds_write_b128 v17, a[40:43] offset:2048
epw_123:
  s_cmp_eq_u32 s77, 3
  s_cbranch_scc1 epw_124
  s_sub_u32 s78, s77, 4
  s_and_b32 s78, s78, 3
  s_lshl_b32 s79, s76, 2
  s_add_u32 s79, s79, 3
  s_mul_i32 s79, s79, 3
  s_add_u32 s79, s79, s78
  s_mul_i32 s79, s79, 3072
  s_add_u32 s79, s79, 0
  v_add_u32 v17, s79, v16
  ds_write_b128 v17, a[48:51] offset:0
  ds_write_b128 v17, a[52:55] offset:1024
  ds_write_b128 v17, a[56:59] offset:2048
epw_124:
  s_cmp_lg_u32 s77, 0
  s_cbranch_scc1 epr_125
  v_accvgpr_read_b32 v20, a0
  v_accvgpr_read_b32 v21, a1
  v_accvgpr_read_b32 v22, a2
  v_accvgpr_read_b32 v23, a3
  v_accvgpr_read_b32 v24, a4
  v_accvgpr_read_b32 v25, a5
  v_accvgpr_read_b32 v26, a6
  v_accvgpr_read_b32 v27, a7
  v_accvgpr_read_b32 v28, a8
  v_accvgpr_read_b32 v29, a9
  v_accvgpr_read_b32 v30, a10
  v_accvgpr_read_b32 v31, a11
  s_branch epr_129
epr_125:
  s_cmp_lg_u32 s77, 1
  s_cbranch_scc1 epr_126
  v_accvgpr_read_b32 v20, a16
  v_accvgpr_read_b32 v21, a17
  v_accvgpr_read_b32 v22, a18
  v_accvgpr_read_b32 v23, a19
  v_accvgpr_read_b32 v24, a20
  v_accvgpr_read_b32 v25, a21
  v_accvgpr_read_b32 v26, a22
  v_accvgpr_read_b32 v27, a23
  v_accvgpr_read_b32 v28, a24
  v_accvgpr_read_b32 v29, a25
  v_accvgpr_read_b32 v30, a26
  v_accvgpr_read_b32 v31, a27
  s_branch epr_129
epr_126:
  s_cmp_lg_u32 s77, 2
  s_cbranch_scc1 epr_127
  v_accvgpr_read_b32 v20, a32
  v_accvgpr_read_b32 v21, a33
  v_accvgpr_read_b32 v22, a34
  v_accvgpr_read_b32 v23, a35
  v_accvgpr_read_b32 v24, a36
  v_accvgpr_read_b32 v25, a37
  v_accvgpr_read_b32 v26, a38
  v_accvgpr_read_b32 v27, a39
  v_accvgpr_read_b32 v28, a40
  v_accvgpr_read_b32 v29, a41
  v_accvgpr_read_b32 v30, a42
  v_accvgpr_read_b32 v31, a43
  s_branch epr_129
epr_127:
  s_cmp_lg_u32 s77, 3
  s_cbranch_scc1 epr_128
  v_accvgpr_read_b32 v20, a48
  v_accvgpr_read_b32 v21, a49
  v_accvgpr_read_b32 v22, a50
  v_accvgpr_read_b32 v23, a51
  v_accvgpr_read_b32 v24, a52
  v_accvgpr_read_b32 v25, a53
  v_accvgpr_read_b32 v26, a54
  v_accvgpr_read_b32 v27, a55
  v_accvgpr_read_b32 v28, a56
  v_accvgpr_read_b32 v29, a57
  v_accvgpr_read_b32 v30, a58
  v_accvgpr_read_b32 v31, a59
  s_branch epr_129
epr_128:
epr_129:
  v_lshrrev_b32 v80, 3, v1
  v_add_u32 v80, 0, v80
  v_and_b32 v81, 3, v80
  v_and_b32 v82, 4, v80
  v_lshl_add_u32 v81, v82, 1, v81
  v_and_b32 v82, 8, v80
  v_lshrrev_b32 v82, 1, v82
  v_add_u32 v81, v81, v82
  s_lshl_b32 s56, s3, 4
  v_add_u32 v81, s56, v81
  v_lshlrev_b32 v112, 12, v81
  v_bfe_u32 v80, v80, 1, 2
  v_bfe_u32 v81, v1, 1, 2
  v_xor_b32 v80, v80, v81
  v_lshl_add_u32 v112, v80, 5, v112
  v_and_b32 v80, 1, v1
  v_lshl_add_u32 v112, v80, 4, v112
  v_lshrrev_b32 v80, 3, v1
  v_add_u32 v80, 8, v80
  v_and_b32 v81, 3, v80
  v_and_b32 v82, 4, v80
  v_lshl_add_u32 v81, v82, 1, v81
  v_and_b32 v82, 8, v80
  v_lshrrev_b32 v82, 1, v82
  v_add_u32 v81, v81, v82
  s_lshl_b32 s56, s3, 4
  v_add_u32 v81, s56, v81
  v_lshlrev_b32 v113, 12, v81
  v_bfe_u32 v80, v80, 1, 2
  v_bfe_u32 v81, v1, 1, 2
  v_xor_b32 v80, v80, v81
  v_lshl_add_u32 v113, v80, 5, v113
  v_and_b32 v80, 1, v1
  v_lshl_add_u32 v113, v80, 4, v113
  v_add_u32 v12, 81920, v14
  v_lshrrev_b32 v80, 1, v3
  v_lshlrev_b32 v80, 4, v80
  v_and_b32 v81, 1, v3
  v_lshl_add_u32 v80, v81, 2, v80
  v_lshrrev_b32 v81, 2, v2
  v_add_u32 v80, v80, v81
  v_lshlrev_b32 v8, 7, v80
  v_bfe_u32 v80, v80, 1, 2
  v_xor_b32 v80, s51, v80
  v_lshl_add_u32 v8, v80, 5, v8
  v_and_b32 v81, 3, v2
  v_lshl_add_u32 v8, v81, 3, v8
  v_add_u32 v8, 0, v8
  s_lshl_b32 s80, s48, 7
  s_add_u32 s80, s80, 9437184
  s_mul_i32 s81, s49, 102400
  s_add_u32 s81, s81, 16777216
  s_cmp_ge_u32 s3, 4
  s_cbranch_scc1 gtp_130
  s_lshl_b32 s56, s3, 10
  s_mul_i32 s57, s4, 20480
  s_add_u32 s57, s57, s81
  s_add_u32 s57, s57, s56
  s_add_u32 s76, s57, 0
  s_add_u32 m0, s56, 81920
  s_nop 0
  buffer_load_dwordx4 v14, s[8:11], s76 offen sc1 lds
  s_add_u32 s76, s57, 4096
  s_add_u32 m0, s56, 86016
  s_nop 0
  buffer_load_dwordx4 v14, s[8:11], s76 offen sc1 lds
  s_add_u32 s76, s57, 8192
  s_add_u32 m0, s56, 90112
  s_nop 0
  buffer_load_dwordx4 v14, s[8:11], s76 offen sc1 lds
  s_add_u32 s76, s57, 12288
  s_add_u32 m0, s56, 94208
  s_nop 0
  buffer_load_dwordx4 v14, s[8:11], s76 offen sc1 lds
  s_add_u32 s76, s57, 16384
  s_add_u32 m0, s56, 98304
  s_nop 0
  buffer_load_dwordx4 v14, s[8:11], s76 offen sc1 lds
  s_mul_i32 s57, s5, 20480
  s_add_u32 s57, s57, s81
  s_add_u32 s57, s57, s56
  s_add_u32 s76, s57, 0
  s_add_u32 m0, s56, 102400
  s_nop 0
  buffer_load_dwordx4 v14, s[8:11], s76 offen sc1 lds
  s_add_u32 s76, s57, 4096
  s_add_u32 m0, s56, 106496
  s_nop 0
  buffer_load_dwordx4 v14, s[8:11], s76 offen sc1 lds
  s_add_u32 s76, s57, 8192
  s_add_u32 m0, s56, 110592
  s_nop 0
  buffer_load_dwordx4 v14, s[8:11], s76 offen sc1 lds
  s_add_u32 s76, s57, 12288
  s_add_u32 m0, s56, 114688
  s_nop 0
  buffer_load_dwordx4 v14, s[8:11], s76 offen sc1 lds
  s_add_u32 s76, s57, 16384
  s_add_u32 m0, s56, 118784
  s_nop 0
  buffer_load_dwordx4 v14, s[8:11], s76 offen sc1 lds
  s_mul_i32 s57, s6, 20480
  s_add_u32 s57, s57, s81
  s_add_u32 s57, s57, s56
  s_add_u32 s76, s57, 0
  s_add_u32 m0, s56, 122880
  s_nop 0
  buffer_load_dwordx4 v14, s[8:11], s76 offen sc1 lds
  s_add_u32 s76, s57, 4096
  s_add_u32 m0, s56, 126976
  s_nop 0
  buffer_load_dwordx4 v14, s[8:11], s76 offen sc1 lds
  s_add_u32 s76, s57, 8192
  s_add_u32 m0, s56, 131072
  s_nop 0
  buffer_load_dwordx4 v14, s[8:11], s76 offen sc1 lds
  s_add_u32 s76, s57, 12288
  s_add_u32 m0, s56, 135168
  s_nop 0
  buffer_load_dwordx4 v14, s[8:11], s76 offen sc1 lds
  s_add_u32 s76, s57, 16384
  s_add_u32 m0, s56, 139264
  s_nop 0
  buffer_load_dwordx4 v14, s[8:11], s76 offen sc1 lds
gtp_130:
  s_cmp_lg_u32 s3, 3
  s_cbranch_scc1 ow_131
  v_lshlrev_b32 v104, 6, v1
  s_mov_b32 s91, 18087936
  s_mov_b32 s90, 0
poll_132:
  s_mov_b32 s92, s91
  buffer_load_dword v105, v104, s[8:11], s92 offen sc1
  s_add_u32 s92, s92, 4096
  buffer_load_dword v106, v104, s[8:11], s92 offen sc1
  s_add_u32 s92, s92, 4096
  buffer_load_dword v107, v104, s[8:11], s92 offen sc1
  s_add_u32 s92, s92, 4096
  buffer_load_dword v108, v104, s[8:11], s92 offen sc1
  s_add_u32 s92, s92, 4096
  buffer_load_dword v109, v104, s[8:11], s92 offen sc1
  s_add_u32 s92, s92, 4096
  buffer_load_dword v110, v104, s[8:11], s92 offen sc1
  s_waitcnt vmcnt(0)
  v_cmp_ne_u32 vcc, s50, v105
  s_mov_b64 s[94:95], vcc
  v_cmp_ne_u32 vcc, s50, v106
  s_or_b64 s[94:95], s[94:95], vcc
  v_cmp_ne_u32 vcc, s50, v107
  s_or_b64 s[94:95], s[94:95], vcc
  v_cmp_ne_u32 vcc, s50, v108
  s_or_b64 s[94:95], s[94:95], vcc
  v_cmp_ne_u32 vcc, s50, v109
  s_or_b64 s[94:95], s[94:95], vcc
  v_mov_b32 v111, s50
  v_cmp_gt_u32 vcc, 1, v1
  s_nop 1
  v_cndmask_b32 v110, v111, v110, vcc
  v_cmp_ne_u32 vcc, s50, v110
  s_or_b64 s[94:95], s[94:95], vcc
  s_cmp_eq_u64 s[94:95], 0
  s_cbranch_scc1 polld_133
  s_add_u32 s90, s90, 1
  s_cmp_ge_u32 s90, 0x40000
  s_cbranch_scc1 polld_133
  s_sleep 12
  s_branch poll_132
polld_133:
ow_131:
  s_and_b32 s76, s3, 1
  s_lshr_b32 s77, s3, 1
  s_lshl_b32 s79, s76, 2
  s_add_u32 s79, s79, s77
  s_mul_i32 s79, s79, 9216
  s_add_u32 s79, s79, 0
  v_add_u32 v17, s79, v16
  s_waitcnt lgkmcnt(0)
  s_barrier
  ds_read_b128 v[32:35], v17 offset:0
  ds_read_b128 v[36:39], v17 offset:1024
  ds_read_b128 v[40:43], v17 offset:2048
  ds_read_b128 v[44:47], v17 offset:3072
  ds_read_b128 v[48:51], v17 offset:4096
  ds_read_b128 v[52:55], v17 offset:5120
  ds_read_b128 v[56:59], v17 offset:6144
  ds_read_b128 v[60:63], v17 offset:7168
  ds_read_b128 v[64:67], v17 offset:8192
  s_waitcnt lgkmcnt(6)
  v_pk_add_f32 v[20:21], v[20:21], v[32:33]
  v_pk_add_f32 v[22:23], v[22:23], v[34:35]
  v_pk_add_f32 v[24:25], v[24:25], v[36:37]
  v_pk_add_f32 v[26:27], v[26:27], v[38:39]
  v_pk_add_f32 v[28:29], v[28:29], v[40:41]
  v_pk_add_f32 v[30:31], v[30:31], v[42:43]
  s_waitcnt lgkmcnt(3)
  v_pk_add_f32 v[20:21], v[20:21], v[44:45]
  v_pk_add_f32 v[22:23], v[22:23], v[46:47]
  v_pk_add_f32 v[24:25], v[24:25], v[48:49]
  v_pk_add_f32 v[26:27], v[26:27], v[50:51]
  v_pk_add_f32 v[28:29], v[28:29], v[52:53]
  v_pk_add_f32 v[30:31], v[30:31], v[54:55]
  s_waitcnt lgkmcnt(0)
  v_pk_add_f32 v[20:21], v[20:21], v[56:57]
  v_pk_add_f32 v[22:23], v[22:23], v[58:59]
  v_pk_add_f32 v[24:25], v[24:25], v[60:61]
  v_pk_add_f32 v[26:27], v[26:27], v[62:63]
  v_pk_add_f32 v[28:29], v[28:29], v[64:65]
  v_pk_add_f32 v[30:31], v[30:31], v[66:67]
  v_mov_b32 v18, v28
  v_mov_b32 v19, v28
  s_nop 1
  v_permlane32_swap_b32 v18, v19
  s_nop 1
  v_rcp_f32 v18, v19
  s_nop 0
  v_pk_mul_f32 v[20:21], v[20:21], v[18:19] op_sel_hi:[1,0]
  v_pk_mul_f32 v[22:23], v[22:23], v[18:19] op_sel_hi:[1,0]
  v_pk_mul_f32 v[24:25], v[24:25], v[18:19] op_sel_hi:[1,0]
  v_pk_mul_f32 v[26:27], v[26:27], v[18:19] op_sel_hi:[1,0]
  v_pk_mul_f32 v[28:29], v[28:29], v[18:19] op_sel_hi:[1,0]
  v_pk_mul_f32 v[30:31], v[30:31], v[18:19] op_sel_hi:[1,0]
  v_cvt_pk_bf16_f32 v32, v20, v21
  v_cvt_pk_bf16_f32 v33, v22, v23
  v_cvt_pk_bf16_f32 v34, v24, v25
  v_cvt_pk_bf16_f32 v35, v26, v27
  v_cvt_pk_bf16_f32 v36, v28, v29
  v_cvt_pk_bf16_f32 v37, v30, v31
  s_mul_i32 s60, s70, 5120
  s_mul_i32 s61, s71, 40
  s_add_u32 s60, s60, s61
  s_add_u32 s60, s60, 143360
  v_mul_u32_u24 v11, 160, v4
  v_lshl_add_u32 v11, v5, 3, v11
  v_add_u32 v11, s60, v11
  ds_write_b64 v11, v[32:33]
  ds_write_b64 v11, v[34:35] offset:16
  v_cmp_gt_u32 vcc, 32, v1
  s_and_saveexec_b64 s[62:63], vcc
  ds_write_b64 v11, v[36:37] offset:32
  s_mov_b64 exec, s[62:63]
  v_mov_b32 v40, 0x21800000
  v_mov_b32 v41, 0x5d800000
  v_cmp_nge_f32 s[60:61], v19, v40
  v_cmp_nle_f32 vcc, v19, v41
  s_nop 1
  s_or_b64 vcc, vcc, s[60:61]
  s_cmp_eq_u64 vcc, 0
  s_cbranch_scc1 lok_134
  v_mov_b32 v40, 162864
  v_mov_b32 v41, 1
  ds_write_b32 v40, v41
lok_134:
  s_waitcnt vmcnt(0) lgkmcnt(0)
  s_barrier
  v_mov_b32 v92, 162864
  ds_read_b32 v93, v92
  v_lshlrev_b32 v80, 4, v0
  v_add_u32 v81, 143360, v80
  ds_read_b128 v[84:87], v81
  ds_read_b128 v[88:91], v81 offset:8192
  s_lshl_b32 s56, s48, 3
  s_add_u32 s56, s56, s49
  s_mul_i32 s56, s56, 10240
  s_add_u32 s56, s56, 3407872
  s_waitcnt lgkmcnt(2)
  v_readfirstlane_b32 s58, v93
  s_cmp_lg_u32 s58, s83
  s_cbranch_scc1 L_slow
  s_waitcnt lgkmcnt(1)
  s_cmp_ge_u32 s3, 2
  s_cbranch_scc1 ost_135
  s_waitcnt lgkmcnt(0)
  s_add_u32 s57, s56, 8192
  buffer_store_dwordx4 v[88:91], v80, s[8:11], s57 offen sc1
ost_135:
  buffer_store_dwordx4 v[84:87], v80, s[8:11], s56 offen sc1
  s_waitcnt lgkmcnt(0)
  s_mul_i32 s76, s4, 524288
  s_add_u32 s76, s76, s80
  s_lshl_b32 s77, s3, 11
  s_add_u32 m0, s77, 0
  s_nop 0
  buffer_load_dwordx4 v112, s[8:11], s76 offen sc1 lds
  s_add_u32 m0, s77, 1024
  s_nop 0
  buffer_load_dwordx4 v113, s[8:11], s76 offen sc1 lds
  s_mul_i32 s76, s5, 524288
  s_add_u32 s76, s76, s80
  s_lshl_b32 s77, s3, 11
  s_add_u32 m0, s77, 16384
  s_nop 0
  buffer_load_dwordx4 v112, s[8:11], s76 offen sc1 lds
  s_add_u32 m0, s77, 17408
  s_nop 0
  buffer_load_dwordx4 v113, s[8:11], s76 offen sc1 lds
  s_waitcnt vmcnt(4)
  v_mov_b32 v80, 162824
  v_mov_b32 v81, 1
  s_mov_b64 s[94:95], exec
  s_mov_b64 exec, 1
  ds_add_rtn_u32 v81, v80, v81
  s_waitcnt lgkmcnt(0)
  v_readfirstlane_b32 s89, v81
  s_mov_b64 exec, s[94:95]
  s_cmp_lg_u32 s89, 7
  s_cbranch_scc1 cnt_136
  s_lshl_b32 s86, s2, 6
  s_add_u32 s86, s86, 18071552
  v_mov_b32 v15, s50
  s_mov_b64 s[88:89], exec
  s_mov_b64 exec, 1
  buffer_store_dword v15, off, s[8:11], s86 sc1
  s_mov_b64 exec, s[88:89]
cnt_136:
  s_mul_i32 s82, s48, 81920
  s_add_u32 s82, s82, 3407872
  s_mul_i32 s83, s49, 102400
  s_add_u32 s83, s83, 1310720
  s_cmp_ge_u32 s3, 4
  s_cbranch_scc1 vb_137
  s_waitcnt vmcnt(2)
  s_barrier
  v_add_u32 v104, 0, v12
  ds_read_b64_tr_b16 v[40:41], v8 offset:0
  ds_read_b64_tr_b16 v[42:43], v8 offset:1024
  ds_read_b128 v[44:47], v104 offset:0
  ds_read_b128 v[48:51], v104 offset:1024
  ds_read_b128 v[52:55], v104 offset:2048
  ds_read_b64_tr_b16 v[60:61], v8 offset:4096
  ds_read_b64_tr_b16 v[62:63], v8 offset:5120
  ds_read_b128 v[64:67], v104 offset:5120
  ds_read_b128 v[68:71], v104 offset:6144
  ds_read_b128 v[72:75], v104 offset:7168
  s_mul_i32 s76, s6, 524288
  s_add_u32 s76, s76, s80
  s_lshl_b32 s77, s3, 11
  s_add_u32 m0, s77, 32768
  s_nop 0
  buffer_load_dwordx4 v112, s[8:11], s76 offen sc1 lds
  s_waitcnt lgkmcnt(5)
  v_mfma_f32_16x16x32_bf16 v[28:31], v[44:47], v[40:43], 0
  v_mfma_f32_16x16x32_bf16 v[32:35], v[48:51], v[40:43], 0
  v_mfma_f32_16x16x32_bf16 v[36:39], v[52:55], v[40:43], 0
  ds_read_b64_tr_b16 v[40:41], v8 offset:8192
  ds_read_b64_tr_b16 v[42:43], v8 offset:9216
  ds_read_b128 v[44:47], v104 offset:10240
  ds_read_b128 v[48:51], v104 offset:11264
  ds_read_b128 v[52:55], v104 offset:12288
  s_mul_i32 s76, s6, 524288
  s_add_u32 s76, s76, s80
  s_lshl_b32 s77, s3, 11
  s_add_u32 m0, s77, 33792
  s_nop 0
  buffer_load_dwordx4 v113, s[8:11], s76 offen sc1 lds
  s_waitcnt lgkmcnt(5)
  v_mfma_f32_16x16x32_bf16 v[28:31], v[64:67], v[60:63], v[28:31]
  v_mfma_f32_16x16x32_bf16 v[32:35], v[68:71], v[60:63], v[32:35]
  v_mfma_f32_16x16x32_bf16 v[36:39], v[72:75], v[60:63], v[36:39]
  ds_read_b64_tr_b16 v[60:61], v8 offset:12288
  ds_read_b64_tr_b16 v[62:63], v8 offset:13312
  ds_read_b128 v[64:67], v104 offset:15360
  ds_read_b128 v[68:71], v104 offset:16384
  ds_read_b128 v[72:75], v104 offset:17408
  s_waitcnt lgkmcnt(5)
  v_mfma_f32_16x16x32_bf16 v[28:31], v[44:47], v[40:43], v[28:31]
  v_mfma_f32_16x16x32_bf16 v[32:35], v[48:51], v[40:43], v[32:35]
  v_mfma_f32_16x16x32_bf16 v[36:39], v[52:55], v[40:43], v[36:39]
  s_waitcnt lgkmcnt(0)
  v_mfma_f32_16x16x32_bf16 v[28:31], v[64:67], v[60:63], v[28:31]
  v_mfma_f32_16x16x32_bf16 v[32:35], v[68:71], v[60:63], v[32:35]
  v_mfma_f32_16x16x32_bf16 v[36:39], v[72:75], v[60:63], v[36:39]
  s_branch ve_138
vb_137:
  s_waitcnt vmcnt(2)
  s_barrier
  v_add_u32 v104, 0, v12
  ds_read_b64_tr_b16 v[40:41], v8 offset:0
  ds_read_b64_tr_b16 v[42:43], v8 offset:1024
  ds_read_b128 v[44:47], v104 offset:3072
  ds_read_b128 v[48:51], v104 offset:4096
  ds_read_b64_tr_b16 v[60:61], v8 offset:4096
  ds_read_b64_tr_b16 v[62:63], v8 offset:5120
  ds_read_b128 v[64:67], v104 offset:8192
  ds_read_b128 v[68:71], v104 offset:9216
  s_mul_i32 s76, s6, 524288
  s_add_u32 s76, s76, s80
  s_lshl_b32 s77, s3, 11
  s_add_u32 m0, s77, 32768
  s_nop 0
  buffer_load_dwordx4 v112, s[8:11], s76 offen sc1 lds
  s_waitcnt lgkmcnt(4)
  v_mfma_f32_16x16x32_bf16 v[28:31], v[44:47], v[40:43], 0
  v_mfma_f32_16x16x32_bf16 v[32:35], v[48:51], v[40:43], 0
  ds_read_b64_tr_b16 v[40:41], v8 offset:8192
  ds_read_b64_tr_b16 v[42:43], v8 offset:9216
  ds_read_b128 v[44:47], v104 offset:13312
  ds_read_b128 v[48:51], v104 offset:14336
  s_mul_i32 s76, s6, 524288
  s_add_u32 s76, s76, s80
  s_lshl_b32 s77, s3, 11
  s_add_u32 m0, s77, 33792
  s_nop 0
  buffer_load_dwordx4 v113, s[8:11], s76 offen sc1 lds
  s_waitcnt lgkmcnt(4)
  v_mfma_f32_16x16x32_bf16 v[28:31], v[64:67], v[60:63], v[28:31]
  v_mfma_f32_16x16x32_bf16 v[32:35], v[68:71], v[60:63], v[32:35]
  ds_read_b64_tr_b16 v[60:61], v8 offset:12288
  ds_read_b64_tr_b16 v[62:63], v8 offset:13312
  ds_read_b128 v[64:67], v104 offset:18432
  ds_read_b128 v[68:71], v104 offset:19456
  s_waitcnt lgkmcnt(4)
  v_mfma_f32_16x16x32_bf16 v[28:31], v[44:47], v[40:43], v[28:31]
  v_mfma_f32_16x16x32_bf16 v[32:35], v[48:51], v[40:43], v[32:35]
  s_waitcnt lgkmcnt(0)
  v_mfma_f32_16x16x32_bf16 v[28:31], v[64:67], v[60:63], v[28:31]
  v_mfma_f32_16x16x32_bf16 v[32:35], v[68:71], v[60:63], v[32:35]
ve_138:
  s_cmp_ge_u32 s3, 4
  s_cbranch_scc1 vb_139
  s_waitcnt vmcnt(2)
  s_barrier
  v_add_u32 v104, 20480, v12
  ds_read_b64_tr_b16 v[40:41], v8 offset:16384
  ds_read_b64_tr_b16 v[42:43], v8 offset:17408
  ds_read_b128 v[44:47], v104 offset:0
  ds_read_b128 v[48:51], v104 offset:1024
  ds_read_b128 v[52:55], v104 offset:2048
  ds_read_b64_tr_b16 v[60:61], v8 offset:20480
  ds_read_b64_tr_b16 v[62:63], v8 offset:21504
  ds_read_b128 v[64:67], v104 offset:5120
  ds_read_b128 v[68:71], v104 offset:6144
  ds_read_b128 v[72:75], v104 offset:7168
  s_mul_i32 s76, s7, 524288
  s_add_u32 s76, s76, s80
  s_lshl_b32 s77, s3, 11
  s_add_u32 m0, s77, 49152
  s_nop 0
  buffer_load_dwordx4 v112, s[8:11], s76 offen sc1 lds
  s_waitcnt lgkmcnt(5)
  v_mfma_f32_16x16x32_bf16 v[28:31], v[44:47], v[40:43], v[28:31]
  v_mfma_f32_16x16x32_bf16 v[32:35], v[48:51], v[40:43], v[32:35]
  v_mfma_f32_16x16x32_bf16 v[36:39], v[52:55], v[40:43], v[36:39]
  ds_read_b64_tr_b16 v[40:41], v8 offset:24576
  ds_read_b64_tr_b16 v[42:43], v8 offset:25600
  ds_read_b128 v[44:47], v104 offset:10240
  ds_read_b128 v[48:51], v104 offset:11264
  ds_read_b128 v[52:55], v104 offset:12288
  s_mul_i32 s76, s7, 524288
  s_add_u32 s76, s76, s80
  s_lshl_b32 s77, s3, 11
  s_add_u32 m0, s77, 50176
  s_nop 0
  buffer_load_dwordx4 v113, s[8:11], s76 offen sc1 lds
  s_waitcnt lgkmcnt(5)
  v_mfma_f32_16x16x32_bf16 v[28:31], v[64:67], v[60:63], v[28:31]
  v_mfma_f32_16x16x32_bf16 v[32:35], v[68:71], v[60:63], v[32:35]
  v_mfma_f32_16x16x32_bf16 v[36:39], v[72:75], v[60:63], v[36:39]
  ds_read_b64_tr_b16 v[60:61], v8 offset:28672
  ds_read_b64_tr_b16 v[62:63], v8 offset:29696
  ds_read_b128 v[64:67], v104 offset:15360
  ds_read_b128 v[68:71], v104 offset:16384
  ds_read_b128 v[72:75], v104 offset:17408
  s_mul_i32 s76, s7, 20480
  s_add_u32 s76, s76, s81
  s_add_u32 s76, s76, s53
  s_add_u32 s76, s76, 0
  s_add_u32 m0, s53, 81920
  s_nop 0
  buffer_load_dwordx4 v14, s[8:11], s76 offen sc1 lds
  s_waitcnt lgkmcnt(5)
  v_mfma_f32_16x16x32_bf16 v[28:31], v[44:47], v[40:43], v[28:31]
  v_mfma_f32_16x16x32_bf16 v[32:35], v[48:51], v[40:43], v[32:35]
  v_mfma_f32_16x16x32_bf16 v[36:39], v[52:55], v[40:43], v[36:39]
  s_mul_i32 s76, s7, 20480
  s_add_u32 s76, s76, s81
  s_add_u32 s76, s76, s53
  s_add_u32 s76, s76, 4096
  s_add_u32 m0, s53, 86016
  s_nop 0
  buffer_load_dwordx4 v14, s[8:11], s76 offen sc1 lds
  s_waitcnt lgkmcnt(0)
  v_mfma_f32_16x16x32_bf16 v[28:31], v[64:67], v[60:63], v[28:31]
  v_mfma_f32_16x16x32_bf16 v[32:35], v[68:71], v[60:63], v[32:35]
  v_mfma_f32_16x16x32_bf16 v[36:39], v[72:75], v[60:63], v[36:39]
  s_branch ve_140
vb_139:
  s_waitcnt vmcnt(2)
  s_barrier
  v_add_u32 v104, 20480, v12
  ds_read_b64_tr_b16 v[40:41], v8 offset:16384
  ds_read_b64_tr_b16 v[42:43], v8 offset:17408
  ds_read_b128 v[44:47], v104 offset:3072
  ds_read_b128 v[48:51], v104 offset:4096
  ds_read_b64_tr_b16 v[60:61], v8 offset:20480
  ds_read_b64_tr_b16 v[62:63], v8 offset:21504
  ds_read_b128 v[64:67], v104 offset:8192
  ds_read_b128 v[68:71], v104 offset:9216
  s_mul_i32 s76, s7, 524288
  s_add_u32 s76, s76, s80
  s_lshl_b32 s77, s3, 11
  s_add_u32 m0, s77, 49152
  s_nop 0
  buffer_load_dwordx4 v112, s[8:11], s76 offen sc1 lds
  s_waitcnt lgkmcnt(4)
  v_mfma_f32_16x16x32_bf16 v[28:31], v[44:47], v[40:43], v[28:31]
  v_mfma_f32_16x16x32_bf16 v[32:35], v[48:51], v[40:43], v[32:35]
  ds_read_b64_tr_b16 v[40:41], v8 offset:24576
  ds_read_b64_tr_b16 v[42:43], v8 offset:25600
  ds_read_b128 v[44:47], v104 offset:13312
  ds_read_b128 v[48:51], v104 offset:14336
  s_mul_i32 s76, s7, 524288
  s_add_u32 s76, s76, s80
  s_lshl_b32 s77, s3, 11
  s_add_u32 m0, s77, 50176
  s_nop 0
  buffer_load_dwordx4 v113, s[8:11], s76 offen sc1 lds
  s_mul_i32 s76, s7, 20480
  s_add_u32 s76, s76, s81
  s_add_u32 s76, s76, s53
  s_add_u32 s76, s76, 4096
  s_add_u32 m0, s53, 86016
  s_nop 0
  buffer_load_dwordx4 v14, s[8:11], s76 offen sc1 lds
  s_waitcnt lgkmcnt(4)
  v_mfma_f32_16x16x32_bf16 v[28:31], v[64:67], v[60:63], v[28:31]
  v_mfma_f32_16x16x32_bf16 v[32:35], v[68:71], v[60:63], v[32:35]
  ds_read_b64_tr_b16 v[60:61], v8 offset:28672
  ds_read_b64_tr_b16 v[62:63], v8 offset:29696
  ds_read_b128 v[64:67], v104 offset:18432
  ds_read_b128 v[68:71], v104 offset:19456
  s_mul_i32 s76, s7, 20480
  s_add_u32 s76, s76, s81
  s_add_u32 s76, s76, s53
  s_add_u32 s76, s76, 8192
  s_add_u32 m0, s53, 90112
  s_nop 0
  buffer_load_dwordx4 v14, s[8:11], s76 offen sc1 lds
  s_mul_i32 s76, s7, 20480
  s_add_u32 s76, s76, s81
  s_add_u32 s76, s76, s53
  s_add_u32 s76, s76, 12288
  s_add_u32 m0, s53, 94208
  s_nop 0
  buffer_load_dwordx4 v14, s[8:11], s76 offen sc1 lds
  s_waitcnt lgkmcnt(4)
  v_mfma_f32_16x16x32_bf16 v[28:31], v[44:47], v[40:43], v[28:31]
  v_mfma_f32_16x16x32_bf16 v[32:35], v[48:51], v[40:43], v[32:35]
  s_cmp_lg_u32 s3, 7
  s_cbranch_scc1 ow_141
  s_and_b32 s56, s48, 7
  s_lshr_b32 s57, s48, 3
  s_lshl_b32 s57, s57, 6
  s_add_u32 s56, s56, s57
  v_min_u32 v96, 7, v1
  v_lshlrev_b32 v96, 9, v96
  s_lshl_b32 s91, s56, 6
  s_add_u32 s91, s91, 18071552
  buffer_load_dword v97, v96, s[8:11], s91 offen sc1
ow_141:
  s_waitcnt lgkmcnt(0)
  v_mfma_f32_16x16x32_bf16 v[28:31], v[64:67], v[60:63], v[28:31]
  v_mfma_f32_16x16x32_bf16 v[32:35], v[68:71], v[60:63], v[32:35]
ve_140:
  s_cmp_ge_u32 s3, 4
  s_cbranch_scc1 vb_142
  s_waitcnt vmcnt(4)
  s_barrier
  v_add_u32 v104, 40960, v12
  ds_read_b64_tr_b16 v[40:41], v8 offset:32768
  ds_read_b64_tr_b16 v[42:43], v8 offset:33792
  ds_read_b128 v[44:47], v104 offset:0
  ds_read_b128 v[48:51], v104 offset:1024
  ds_read_b128 v[52:55], v104 offset:2048
  ds_read_b64_tr_b16 v[60:61], v8 offset:36864
  ds_read_b64_tr_b16 v[62:63], v8 offset:37888
  ds_read_b128 v[64:67], v104 offset:5120
  ds_read_b128 v[68:71], v104 offset:6144
  ds_read_b128 v[72:75], v104 offset:7168
  s_mul_i32 s76, s54, 524288
  s_add_u32 s76, s76, s80
  s_lshl_b32 s77, s3, 11
  s_add_u32 m0, s77, 65536
  s_nop 0
  buffer_load_dwordx4 v112, s[8:11], s76 offen sc1 lds
  s_waitcnt lgkmcnt(5)
  v_mfma_f32_16x16x32_bf16 v[28:31], v[44:47], v[40:43], v[28:31]
  v_mfma_f32_16x16x32_bf16 v[32:35], v[48:51], v[40:43], v[32:35]
  v_mfma_f32_16x16x32_bf16 v[36:39], v[52:55], v[40:43], v[36:39]
  ds_read_b64_tr_b16 v[40:41], v8 offset:40960
  ds_read_b64_tr_b16 v[42:43], v8 offset:41984
  ds_read_b128 v[44:47], v104 offset:10240
  ds_read_b128 v[48:51], v104 offset:11264
  ds_read_b128 v[52:55], v104 offset:12288
  s_mul_i32 s76, s54, 524288
  s_add_u32 s76, s76, s80
  s_lshl_b32 s77, s3, 11
  s_add_u32 m0, s77, 66560
  s_nop 0
  buffer_load_dwordx4 v113, s[8:11], s76 offen sc1 lds
  s_waitcnt lgkmcnt(5)
  v_mfma_f32_16x16x32_bf16 v[28:31], v[64:67], v[60:63], v[28:31]
  v_mfma_f32_16x16x32_bf16 v[32:35], v[68:71], v[60:63], v[32:35]
  v_mfma_f32_16x16x32_bf16 v[36:39], v[72:75], v[60:63], v[36:39]
  ds_read_b64_tr_b16 v[60:61], v8 offset:45056
  ds_read_b64_tr_b16 v[62:63], v8 offset:46080
  ds_read_b128 v[64:67], v104 offset:15360
  ds_read_b128 v[68:71], v104 offset:16384
  ds_read_b128 v[72:75], v104 offset:17408
  s_mul_i32 s76, s54, 20480
  s_add_u32 s76, s76, s81
  s_add_u32 s76, s76, s53
  s_add_u32 s76, s76, 0
  s_add_u32 m0, s53, 102400
  s_nop 0
  buffer_load_dwordx4 v14, s[8:11], s76 offen sc1 lds
  s_waitcnt lgkmcnt(5)
  v_mfma_f32_16x16x32_bf16 v[28:31], v[44:47], v[40:43], v[28:31]
  v_mfma_f32_16x16x32_bf16 v[32:35], v[48:51], v[40:43], v[32:35]
  v_mfma_f32_16x16x32_bf16 v[36:39], v[52:55], v[40:43], v[36:39]
  s_mul_i32 s76, s54, 20480
  s_add_u32 s76, s76, s81
  s_add_u32 s76, s76, s53
  s_add_u32 s76, s76, 4096
  s_add_u32 m0, s53, 106496
  s_nop 0
  buffer_load_dwordx4 v14, s[8:11], s76 offen sc1 lds
  s_waitcnt lgkmcnt(0)
  v_mfma_f32_16x16x32_bf16 v[28:31], v[64:67], v[60:63], v[28:31]
  v_mfma_f32_16x16x32_bf16 v[32:35], v[68:71], v[60:63], v[32:35]
  v_mfma_f32_16x16x32_bf16 v[36:39], v[72:75], v[60:63], v[36:39]
  s_branch ve_143
vb_142:
  s_cmp_eq_u32 s3, 7
  s_cbranch_scc1 vw_144
  s_waitcnt vmcnt(5)
  s_branch vw_145
vw_144:
  s_waitcnt vmcnt(6)
vw_145:
  s_barrier
  v_add_u32 v104, 40960, v12
  ds_read_b64_tr_b16 v[40:41], v8 offset:32768
  ds_read_b64_tr_b16 v[42:43], v8 offset:33792
  ds_read_b128 v[44:47], v104 offset:3072
  ds_read_b128 v[48:51], v104 offset:4096
  ds_read_b64_tr_b16 v[60:61], v8 offset:36864
  ds_read_b64_tr_b16 v[62:63], v8 offset:37888
  ds_read_b128 v[64:67], v104 offset:8192
  ds_read_b128 v[68:71], v104 offset:9216
  s_mul_i32 s76, s54, 524288
  s_add_u32 s76, s76, s80
  s_lshl_b32 s77, s3, 11
  s_add_u32 m0, s77, 65536
  s_nop 0
  buffer_load_dwordx4 v112, s[8:11], s76 offen sc1 lds
  s_waitcnt lgkmcnt(4)
  v_mfma_f32_16x16x32_bf16 v[28:31], v[44:47], v[40:43], v[28:31]
  v_mfma_f32_16x16x32_bf16 v[32:35], v[48:51], v[40:43], v[32:35]
  ds_read_b64_tr_b16 v[40:41], v8 offset:40960
  ds_read_b64_tr_b16 v[42:43], v8 offset:41984
  ds_read_b128 v[44:47], v104 offset:13312
  ds_read_b128 v[48:51], v104 offset:14336
  s_mul_i32 s76, s54, 524288
  s_add_u32 s76, s76, s80
  s_lshl_b32 s77, s3, 11
  s_add_u32 m0, s77, 66560
  s_nop 0
  buffer_load_dwordx4 v113, s[8:11], s76 offen sc1 lds
  s_mul_i32 s76, s54, 20480
  s_add_u32 s76, s76, s81
  s_add_u32 s76, s76, s53
  s_add_u32 s76, s76, 4096
  s_add_u32 m0, s53, 106496
  s_nop 0
  buffer_load_dwordx4 v14, s[8:11], s76 offen sc1 lds
  s_waitcnt lgkmcnt(4)
  v_mfma_f32_16x16x32_bf16 v[28:31], v[64:67], v[60:63], v[28:31]
  v_mfma_f32_16x16x32_bf16 v[32:35], v[68:71], v[60:63], v[32:35]
  ds_read_b64_tr_b16 v[60:61], v8 offset:45056
  ds_read_b64_tr_b16 v[62:63], v8 offset:46080
  ds_read_b128 v[64:67], v104 offset:18432
  ds_read_b128 v[68:71], v104 offset:19456
  s_mul_i32 s76, s54, 20480
  s_add_u32 s76, s76, s81
  s_add_u32 s76, s76, s53
  s_add_u32 s76, s76, 8192
  s_add_u32 m0, s53, 110592
  s_nop 0
  buffer_load_dwordx4 v14, s[8:11], s76 offen sc1 lds
  s_waitcnt lgkmcnt(4)
  v_mfma_f32_16x16x32_bf16 v[28:31], v[44:47], v[40:43], v[28:31]
  v_mfma_f32_16x16x32_bf16 v[32:35], v[48:51], v[40:43], v[32:35]
  s_mul_i32 s76, s54, 20480
  s_add_u32 s76, s76, s81
  s_add_u32 s76, s76, s53
  s_add_u32 s76, s76, 12288
  s_add_u32 m0, s53, 114688
  s_nop 0
  buffer_load_dwordx4 v14, s[8:11], s76 offen sc1 lds
  s_waitcnt lgkmcnt(0)
  v_mfma_f32_16x16x32_bf16 v[28:31], v[64:67], v[60:63], v[28:31]
  v_mfma_f32_16x16x32_bf16 v[32:35], v[68:71], v[60:63], v[32:35]
ve_143:
  s_cmp_ge_u32 s3, 4
  s_cbranch_scc1 vb_146
  s_waitcnt vmcnt(4)
  s_barrier
  v_add_u32 v104, 0, v12
  ds_read_b64_tr_b16 v[40:41], v8 offset:49152
  ds_read_b64_tr_b16 v[42:43], v8 offset:50176
  ds_read_b128 v[44:47], v104 offset:0
  ds_read_b128 v[48:51], v104 offset:1024
  ds_read_b128 v[52:55], v104 offset:2048
  ds_read_b64_tr_b16 v[60:61], v8 offset:53248
  ds_read_b64_tr_b16 v[62:63], v8 offset:54272
  ds_read_b128 v[64:67], v104 offset:5120
  ds_read_b128 v[68:71], v104 offset:6144
  ds_read_b128 v[72:75], v104 offset:7168
  s_mul_i32 s76, s4, 20480
  s_add_u32 s76, s76, s83
  s_add_u32 s76, s76, s53
  s_add_u32 s76, s76, 0
  s_add_u32 m0, s53, 122880
  s_nop 0
  buffer_load_dwordx4 v14, s[8:11], s76 offen sc1 lds
  s_waitcnt lgkmcnt(5)
  v_mfma_f32_16x16x32_bf16 v[28:31], v[44:47], v[40:43], v[28:31]
  v_mfma_f32_16x16x32_bf16 v[32:35], v[48:51], v[40:43], v[32:35]
  v_mfma_f32_16x16x32_bf16 v[36:39], v[52:55], v[40:43], v[36:39]
  ds_read_b64_tr_b16 v[40:41], v8 offset:57344
  ds_read_b64_tr_b16 v[42:43], v8 offset:58368
  ds_read_b128 v[44:47], v104 offset:10240
  ds_read_b128 v[48:51], v104 offset:11264
  ds_read_b128 v[52:55], v104 offset:12288
  s_mul_i32 s76, s4, 20480
  s_add_u32 s76, s76, s83
  s_add_u32 s76, s76, s53
  s_add_u32 s76, s76, 4096
  s_add_u32 m0, s53, 126976
  s_nop 0
  buffer_load_dwordx4 v14, s[8:11], s76 offen sc1 lds
  s_waitcnt lgkmcnt(5)
  v_mfma_f32_16x16x32_bf16 v[28:31], v[64:67], v[60:63], v[28:31]
  v_mfma_f32_16x16x32_bf16 v[32:35], v[68:71], v[60:63], v[32:35]
  v_mfma_f32_16x16x32_bf16 v[36:39], v[72:75], v[60:63], v[36:39]
  ds_read_b64_tr_b16 v[60:61], v8 offset:61440
  ds_read_b64_tr_b16 v[62:63], v8 offset:62464
  ds_read_b128 v[64:67], v104 offset:15360
  ds_read_b128 v[68:71], v104 offset:16384
  ds_read_b128 v[72:75], v104 offset:17408
  s_lshl_b32 s56, s3, 2
  v_add_u32 v88, s56, v3
  v_and_b32 v89, 15, v88
  v_xor_b32 v89, v89, v2
  s_lshl_b32 s57, s4, 4
  v_add_u32 v89, s57, v89
  v_mul_u32_u24 v90, 205, v89
  v_lshrrev_b32 v90, 11, v90
  v_mul_u32_u24 v91, 10, v90
  v_sub_u32 v89, v89, v91
  v_mul_u32_u24 v90, 10240, v90
  v_lshl_add_u32 v90, v89, 4, v90
  v_mul_u32_u24 v88, 160, v88
  v_add_u32 v94, v88, v90
  s_add_u32 m0, s53, 0
  s_nop 0
  buffer_load_dwordx4 v94, s[8:11], s82 offen sc1 lds
  s_waitcnt lgkmcnt(5)
  v_mfma_f32_16x16x32_bf16 v[28:31], v[44:47], v[40:43], v[28:31]
  v_mfma_f32_16x16x32_bf16 v[32:35], v[48:51], v[40:43], v[32:35]
  v_mfma_f32_16x16x32_bf16 v[36:39], v[52:55], v[40:43], v[36:39]
  s_add_u32 s76, s82, 5120
  s_add_u32 m0, s53, 8192
  s_nop 0
  buffer_load_dwordx4 v94, s[8:11], s76 offen sc1 lds
  s_waitcnt lgkmcnt(0)
  v_mfma_f32_16x16x32_bf16 v[28:31], v[64:67], v[60:63], v[28:31]
  v_mfma_f32_16x16x32_bf16 v[32:35], v[68:71], v[60:63], v[32:35]
  v_mfma_f32_16x16x32_bf16 v[36:39], v[72:75], v[60:63], v[36:39]
  s_branch ve_147
vb_146:
  s_waitcnt vmcnt(5)
  s_cmp_lg_u32 s3, 7
  s_cbranch_scc1 ow_148
  v_cmp_ne_u32 vcc, s50, v97
  s_cmp_eq_u64 vcc, 0
  s_cbranch_scc1 po_149
  s_and_b32 s56, s48, 7
  s_lshr_b32 s57, s48, 3
  s_lshl_b32 s57, s57, 6
  s_add_u32 s56, s56, s57
  v_min_u32 v96, 7, v1
  v_mul_u32_u24 v96, 512, v96
  s_lshl_b32 s91, s56, 6
  s_add_u32 s91, s91, 18071552
  s_mov_b32 s90, 0
poll_150:
  buffer_load_dword v97, v96, s[8:11], s91 offen sc1
  s_waitcnt vmcnt(0)
  v_cmp_ne_u32 vcc, s50, v97
  s_cmp_eq_u64 vcc, 0
  s_cbranch_scc1 polld_151
  s_add_u32 s90, s90, 1
  s_cmp_ge_u32 s90, 0x40000
  s_cbranch_scc1 polld_151
  s_sleep 1
  s_branch poll_150
polld_151:
po_149:
ow_148:
  s_barrier
  v_add_u32 v104, 0, v12
  ds_read_b64_tr_b16 v[40:41], v8 offset:49152
  ds_read_b64_tr_b16 v[42:43], v8 offset:50176
  ds_read_b128 v[44:47], v104 offset:3072
  ds_read_b128 v[48:51], v104 offset:4096
  ds_read_b64_tr_b16 v[60:61], v8 offset:53248
  ds_read_b64_tr_b16 v[62:63], v8 offset:54272
  ds_read_b128 v[64:67], v104 offset:8192
  ds_read_b128 v[68:71], v104 offset:9216
  s_mul_i32 s76, s4, 20480
  s_add_u32 s76, s76, s83
  s_add_u32 s76, s76, s53
  s_add_u32 s76, s76, 4096
  s_add_u32 m0, s53, 126976
  s_nop 0
  buffer_load_dwordx4 v14, s[8:11], s76 offen sc1 lds
  s_waitcnt lgkmcnt(4)
  v_mfma_f32_16x16x32_bf16 v[28:31], v[44:47], v[40:43], v[28:31]
  v_mfma_f32_16x16x32_bf16 v[32:35], v[48:51], v[40:43], v[32:35]
  ds_read_b64_tr_b16 v[40:41], v8 offset:57344
  ds_read_b64_tr_b16 v[42:43], v8 offset:58368
  ds_read_b128 v[44:47], v104 offset:13312
  ds_read_b128 v[48:51], v104 offset:14336
  s_mul_i32 s76, s4, 20480
  s_add_u32 s76, s76, s83
  s_add_u32 s76, s76, s53
  s_add_u32 s76, s76, 8192
  s_add_u32 m0, s53, 131072
  s_nop 0
  buffer_load_dwordx4 v14, s[8:11], s76 offen sc1 lds
  s_mul_i32 s76, s4, 20480
  s_add_u32 s76, s76, s83
  s_add_u32 s76, s76, s53
  s_add_u32 s76, s76, 12288
  s_add_u32 m0, s53, 135168
  s_nop 0
  buffer_load_dwordx4 v14, s[8:11], s76 offen sc1 lds
  s_waitcnt lgkmcnt(4)
  v_mfma_f32_16x16x32_bf16 v[28:31], v[64:67], v[60:63], v[28:31]
  v_mfma_f32_16x16x32_bf16 v[32:35], v[68:71], v[60:63], v[32:35]
  ds_read_b64_tr_b16 v[60:61], v8 offset:61440
  ds_read_b64_tr_b16 v[62:63], v8 offset:62464
  ds_read_b128 v[64:67], v104 offset:18432
  ds_read_b128 v[68:71], v104 offset:19456
  s_lshl_b32 s56, s3, 2
  v_add_u32 v88, s56, v3
  v_and_b32 v89, 15, v88
  v_xor_b32 v89, v89, v2
  s_lshl_b32 s57, s4, 4
  v_add_u32 v89, s57, v89
  v_mul_u32_u24 v90, 205, v89
  v_lshrrev_b32 v90, 11, v90
  v_mul_u32_u24 v91, 10, v90
  v_sub_u32 v89, v89, v91
  v_mul_u32_u24 v90, 10240, v90
  v_lshl_add_u32 v90, v89, 4, v90
  v_mul_u32_u24 v88, 160, v88
  v_add_u32 v94, v88, v90
  s_add_u32 m0, s53, 0
  s_nop 0
  buffer_load_dwordx4 v94, s[8:11], s82 offen sc1 lds
  s_waitcnt lgkmcnt(4)
  v_mfma_f32_16x16x32_bf16 v[28:31], v[44:47], v[40:43], v[28:31]
  v_mfma_f32_16x16x32_bf16 v[32:35], v[48:51], v[40:43], v[32:35]
  s_add_u32 s76, s82, 5120
  s_add_u32 m0, s53, 8192
  s_nop 0
  buffer_load_dwordx4 v94, s[8:11], s76 offen sc1 lds
  s_waitcnt lgkmcnt(0)
  v_mfma_f32_16x16x32_bf16 v[28:31], v[64:67], v[60:63], v[28:31]
  v_mfma_f32_16x16x32_bf16 v[32:35], v[68:71], v[60:63], v[32:35]
ve_147:
  s_cmp_ge_u32 s3, 4
  s_cbranch_scc1 vb_152
  s_waitcnt vmcnt(4)
  s_barrier
  v_add_u32 v104, 20480, v12
  v_add_u32 v80, 65536, v8
  ds_read_b64_tr_b16 v[40:41], v80 offset:0
  ds_read_b64_tr_b16 v[42:43], v80 offset:1024
  ds_read_b128 v[44:47], v104 offset:0
  ds_read_b128 v[48:51], v104 offset:1024
  ds_read_b128 v[52:55], v104 offset:2048
  ds_read_b64_tr_b16 v[60:61], v80 offset:4096
  ds_read_b64_tr_b16 v[62:63], v80 offset:5120
  ds_read_b128 v[64:67], v104 offset:5120
  ds_read_b128 v[68:71], v104 offset:6144
  ds_read_b128 v[72:75], v104 offset:7168
  s_mul_i32 s76, s5, 20480
  s_add_u32 s76, s76, s83
  s_add_u32 s76, s76, s53
  s_add_u32 s76, s76, 0
  s_add_u32 m0, s53, 81920
  s_nop 0
  buffer_load_dwordx4 v14, s[8:11], s76 offen sc1 lds
  s_waitcnt lgkmcnt(5)
  v_mfma_f32_16x16x32_bf16 v[28:31], v[44:47], v[40:43], v[28:31]
  v_mfma_f32_16x16x32_bf16 v[32:35], v[48:51], v[40:43], v[32:35]
  v_mfma_f32_16x16x32_bf16 v[36:39], v[52:55], v[40:43], v[36:39]
  ds_read_b64_tr_b16 v[40:41], v80 offset:8192
  ds_read_b64_tr_b16 v[42:43], v80 offset:9216
  ds_read_b128 v[44:47], v104 offset:10240
  ds_read_b128 v[48:51], v104 offset:11264
  ds_read_b128 v[52:55], v104 offset:12288
  s_mul_i32 s76, s5, 20480
  s_add_u32 s76, s76, s83
  s_add_u32 s76, s76, s53
  s_add_u32 s76, s76, 4096
  s_add_u32 m0, s53, 86016
  s_nop 0
  buffer_load_dwordx4 v14, s[8:11], s76 offen sc1 lds
  s_waitcnt lgkmcnt(5)
  v_mfma_f32_16x16x32_bf16 v[28:31], v[64:67], v[60:63], v[28:31]
  v_mfma_f32_16x16x32_bf16 v[32:35], v[68:71], v[60:63], v[32:35]
  v_mfma_f32_16x16x32_bf16 v[36:39], v[72:75], v[60:63], v[36:39]
  ds_read_b64_tr_b16 v[60:61], v80 offset:12288
  ds_read_b64_tr_b16 v[62:63], v80 offset:13312
  ds_read_b128 v[64:67], v104 offset:15360
  ds_read_b128 v[68:71], v104 offset:16384
  ds_read_b128 v[72:75], v104 offset:17408
  s_lshl_b32 s56, s3, 2
  v_add_u32 v88, s56, v3
  v_and_b32 v89, 15, v88
  v_xor_b32 v89, v89, v2
  s_lshl_b32 s57, s5, 4
  v_add_u32 v89, s57, v89
  v_mul_u32_u24 v90, 205, v89
  v_lshrrev_b32 v90, 11, v90
  v_mul_u32_u24 v91, 10, v90
  v_sub_u32 v89, v89, v91
  v_mul_u32_u24 v90, 10240, v90
  v_lshl_add_u32 v90, v89, 4, v90
  v_mul_u32_u24 v88, 160, v88
  v_add_u32 v94, v88, v90
  s_add_u32 m0, s53, 16384
  s_nop 0
  buffer_load_dwordx4 v94, s[8:11], s82 offen sc1 lds
  s_waitcnt lgkmcnt(5)
  v_mfma_f32_16x16x32_bf16 v[28:31], v[44:47], v[40:43], v[28:31]
  v_mfma_f32_16x16x32_bf16 v[32:35], v[48:51], v[40:43], v[32:35]
  v_mfma_f32_16x16x32_bf16 v[36:39], v[52:55], v[40:43], v[36:39]
  s_add_u32 s76, s82, 5120
  s_add_u32 m0, s53, 24576
  s_nop 0
  buffer_load_dwordx4 v94, s[8:11], s76 offen sc1 lds
  s_waitcnt lgkmcnt(0)
  v_mfma_f32_16x16x32_bf16 v[28:31], v[64:67], v[60:63], v[28:31]
  v_mfma_f32_16x16x32_bf16 v[32:35], v[68:71], v[60:63], v[32:35]
  v_mfma_f32_16x16x32_bf16 v[36:39], v[72:75], v[60:63], v[36:39]
  s_branch ve_153
vb_152:
  s_waitcnt vmcnt(5)
  s_barrier
  v_add_u32 v104, 20480, v12
  v_add_u32 v80, 65536, v8
  ds_read_b64_tr_b16 v[40:41], v80 offset:0
  ds_read_b64_tr_b16 v[42:43], v80 offset:1024
  ds_read_b128 v[44:47], v104 offset:3072
  ds_read_b128 v[48:51], v104 offset:4096
  ds_read_b64_tr_b16 v[60:61], v80 offset:4096
  ds_read_b64_tr_b16 v[62:63], v80 offset:5120
  ds_read_b128 v[64:67], v104 offset:8192
  ds_read_b128 v[68:71], v104 offset:9216
  s_mul_i32 s76, s5, 20480
  s_add_u32 s76, s76, s83
  s_add_u32 s76, s76, s53
  s_add_u32 s76, s76, 4096
  s_add_u32 m0, s53, 86016
  s_nop 0
  buffer_load_dwordx4 v14, s[8:11], s76 offen sc1 lds
  s_waitcnt lgkmcnt(4)
  v_mfma_f32_16x16x32_bf16 v[28:31], v[44:47], v[40:43], v[28:31]
  v_mfma_f32_16x16x32_bf16 v[32:35], v[48:51], v[40:43], v[32:35]
  ds_read_b64_tr_b16 v[40:41], v80 offset:8192
  ds_read_b64_tr_b16 v[42:43], v80 offset:9216
  ds_read_b128 v[44:47], v104 offset:13312
  ds_read_b128 v[48:51], v104 offset:14336
  s_mul_i32 s76, s5, 20480
  s_add_u32 s76, s76, s83
  s_add_u32 s76, s76, s53
  s_add_u32 s76, s76, 8192
  s_add_u32 m0, s53, 90112
  s_nop 0
  buffer_load_dwordx4 v14, s[8:11], s76 offen sc1 lds
  s_mul_i32 s76, s5, 20480
  s_add_u32 s76, s76, s83
  s_add_u32 s76, s76, s53
  s_add_u32 s76, s76, 12288
  s_add_u32 m0, s53, 94208
  s_nop 0
  buffer_load_dwordx4 v14, s[8:11], s76 offen sc1 lds
  s_waitcnt lgkmcnt(4)
  v_mfma_f32_16x16x32_bf16 v[28:31], v[64:67], v[60:63], v[28:31]
  v_mfma_f32_16x16x32_bf16 v[32:35], v[68:71], v[60:63], v[32:35]
  ds_read_b64_tr_b16 v[60:61], v80 offset:12288
  ds_read_b64_tr_b16 v[62:63], v80 offset:13312
  ds_read_b128 v[64:67], v104 offset:18432
  ds_read_b128 v[68:71], v104 offset:19456
  s_lshl_b32 s56, s3, 2
  v_add_u32 v88, s56, v3
  v_and_b32 v89, 15, v88
  v_xor_b32 v89, v89, v2
  s_lshl_b32 s57, s5, 4
  v_add_u32 v89, s57, v89
  v_mul_u32_u24 v90, 205, v89
  v_lshrrev_b32 v90, 11, v90
  v_mul_u32_u24 v91, 10, v90
  v_sub_u32 v89, v89, v91
  v_mul_u32_u24 v90, 10240, v90
  v_lshl_add_u32 v90, v89, 4, v90
  v_mul_u32_u24 v88, 160, v88
  v_add_u32 v94, v88, v90
  s_add_u32 m0, s53, 16384
  s_nop 0
  buffer_load_dwordx4 v94, s[8:11], s82 offen sc1 lds
  s_waitcnt lgkmcnt(4)
  v_mfma_f32_16x16x32_bf16 v[28:31], v[44:47], v[40:43], v[28:31]
  v_mfma_f32_16x16x32_bf16 v[32:35], v[48:51], v[40:43], v[32:35]
  s_add_u32 s76, s82, 5120
  s_add_u32 m0, s53, 24576
  s_nop 0
  buffer_load_dwordx4 v94, s[8:11], s76 offen sc1 lds
  s_waitcnt lgkmcnt(0)
  v_mfma_f32_16x16x32_bf16 v[28:31], v[64:67], v[60:63], v[28:31]
  v_mfma_f32_16x16x32_bf16 v[32:35], v[68:71], v[60:63], v[32:35]
ve_153:
  v_and_b32 v84, 3, v2
  v_xor_b32 v84, v84, v3
  v_lshlrev_b32 v84, 4, v84
  v_lshl_add_u32 v84, v2, 8, v84
  s_lshl_b32 s56, s51, 12
  s_add_u32 s56, s56, 0
  v_add_u32 v84, s56, v84
  v_lshrrev_b32 v85, 2, v2
  v_xor_b32 v8, 0, v85
  v_lshl_add_u32 v8, v8, 6, v84
  v_xor_b32 v9, 1, v85
  v_lshl_add_u32 v9, v9, 6, v84
  v_xor_b32 v10, 2, v85
  v_lshl_add_u32 v10, v10, 6, v84
  v_xor_b32 v11, 3, v85
  v_lshl_add_u32 v11, v11, 6, v84
  s_cmp_ge_u32 s3, 4
  s_cbranch_scc1 vb_154
  s_waitcnt vmcnt(4)
  s_barrier
  v_add_u32 v104, 40960, v12
  ds_read_b128 v[40:43], v8 offset:0
  ds_read_b128 v[44:47], v104 offset:0
  ds_read_b128 v[48:51], v104 offset:1024
  ds_read_b128 v[52:55], v104 offset:2048
  ds_read_b128 v[60:63], v9 offset:0
  ds_read_b128 v[64:67], v104 offset:5120
  ds_read_b128 v[68:71], v104 offset:6144
  ds_read_b128 v[72:75], v104 offset:7168
  s_mul_i32 s76, s6, 20480
  s_add_u32 s76, s76, s83
  s_add_u32 s76, s76, s53
  s_add_u32 s76, s76, 0
  s_add_u32 m0, s53, 102400
  s_nop 0
  buffer_load_dwordx4 v14, s[8:11], s76 offen sc1 lds
  s_waitcnt lgkmcnt(4)
  v_mfma_f32_16x16x32_bf16 v[16:19], v[44:47], v[40:43], 0
  v_mfma_f32_16x16x32_bf16 v[20:23], v[48:51], v[40:43], 0
  v_mfma_f32_16x16x32_bf16 v[24:27], v[52:55], v[40:43], 0
  ds_read_b128 v[40:43], v10 offset:0
  ds_read_b128 v[44:47], v104 offset:10240
  ds_read_b128 v[48:51], v104 offset:11264
  ds_read_b128 v[52:55], v104 offset:12288
  s_mul_i32 s76, s6, 20480
  s_add_u32 s76, s76, s83
  s_add_u32 s76, s76, s53
  s_add_u32 s76, s76, 4096
  s_add_u32 m0, s53, 106496
  s_nop 0
  buffer_load_dwordx4 v14, s[8:11], s76 offen sc1 lds
  s_waitcnt lgkmcnt(4)
  v_mfma_f32_16x16x32_bf16 v[16:19], v[64:67], v[60:63], v[16:19]
  v_mfma_f32_16x16x32_bf16 v[20:23], v[68:71], v[60:63], v[20:23]
  v_mfma_f32_16x16x32_bf16 v[24:27], v[72:75], v[60:63], v[24:27]
  ds_read_b128 v[60:63], v11 offset:0
  ds_read_b128 v[64:67], v104 offset:15360
  ds_read_b128 v[68:71], v104 offset:16384
  ds_read_b128 v[72:75], v104 offset:17408
  s_lshl_b32 s56, s3, 2
  v_add_u32 v88, s56, v3
  v_and_b32 v89, 15, v88
  v_xor_b32 v89, v89, v2
  s_lshl_b32 s57, s6, 4
  v_add_u32 v89, s57, v89
  v_mul_u32_u24 v90, 205, v89
  v_lshrrev_b32 v90, 11, v90
  v_mul_u32_u24 v91, 10, v90
  v_sub_u32 v89, v89, v91
  v_mul_u32_u24 v90, 10240, v90
  v_lshl_add_u32 v90, v89, 4, v90
  v_mul_u32_u24 v88, 160, v88
  v_add_u32 v94, v88, v90
  s_add_u32 m0, s53, 32768
  s_nop 0
  buffer_load_dwordx4 v94, s[8:11], s82 offen sc1 lds
  s_waitcnt lgkmcnt(4)
  v_mfma_f32_16x16x32_bf16 v[16:19], v[44:47], v[40:43], v[16:19]
  v_mfma_f32_16x16x32_bf16 v[20:23], v[48:51], v[40:43], v[20:23]
  v_mfma_f32_16x16x32_bf16 v[24:27], v[52:55], v[40:43], v[24:27]
  s_add_u32 s76, s82, 5120
  s_add_u32 m0, s53, 40960
  s_nop 0
  buffer_load_dwordx4 v94, s[8:11], s76 offen sc1 lds
  s_waitcnt lgkmcnt(0)
  v_mfma_f32_16x16x32_bf16 v[16:19], v[64:67], v[60:63], v[16:19]
  v_mfma_f32_16x16x32_bf16 v[20:23], v[68:71], v[60:63], v[20:23]
  v_mfma_f32_16x16x32_bf16 v[24:27], v[72:75], v[60:63], v[24:27]
  s_branch ve_155
vb_154:
  s_waitcnt vmcnt(5)
  s_barrier
  v_add_u32 v104, 40960, v12
  ds_read_b128 v[40:43], v8 offset:0
  ds_read_b128 v[44:47], v104 offset:3072
  ds_read_b128 v[48:51], v104 offset:4096
  ds_read_b128 v[60:63], v9 offset:0
  ds_read_b128 v[64:67], v104 offset:8192
  ds_read_b128 v[68:71], v104 offset:9216
  s_mul_i32 s76, s6, 20480
  s_add_u32 s76, s76, s83
  s_add_u32 s76, s76, s53
  s_add_u32 s76, s76, 4096
  s_add_u32 m0, s53, 106496
  s_nop 0
  buffer_load_dwordx4 v14, s[8:11], s76 offen sc1 lds
  s_waitcnt lgkmcnt(3)
  v_mfma_f32_16x16x32_bf16 v[16:19], v[44:47], v[40:43], 0
  v_mfma_f32_16x16x32_bf16 v[20:23], v[48:51], v[40:43], 0
  ds_read_b128 v[40:43], v10 offset:0
  ds_read_b128 v[44:47], v104 offset:13312
  ds_read_b128 v[48:51], v104 offset:14336
  s_mul_i32 s76, s6, 20480
  s_add_u32 s76, s76, s83
  s_add_u32 s76, s76, s53
  s_add_u32 s76, s76, 8192
  s_add_u32 m0, s53, 110592
  s_nop 0
  buffer_load_dwordx4 v14, s[8:11], s76 offen sc1 lds
  s_mul_i32 s76, s6, 20480
  s_add_u32 s76, s76, s83
  s_add_u32 s76, s76, s53
  s_add_u32 s76, s76, 12288
  s_add_u32 m0, s53, 114688
  s_nop 0
  buffer_load_dwordx4 v14, s[8:11], s76 offen sc1 lds
  s_waitcnt lgkmcnt(3)
  v_mfma_f32_16x16x32_bf16 v[16:19], v[64:67], v[60:63], v[16:19]
  v_mfma_f32_16x16x32_bf16 v[20:23], v[68:71], v[60:63], v[20:23]
  ds_read_b128 v[60:63], v11 offset:0
  ds_read_b128 v[64:67], v104 offset:18432
  ds_read_b128 v[68:71], v104 offset:19456
  s_lshl_b32 s56, s3, 2
  v_add_u32 v88, s56, v3
  v_and_b32 v89, 15, v88
  v_xor_b32 v89, v89, v2
  s_lshl_b32 s57, s6, 4
  v_add_u32 v89, s57, v89
  v_mul_u32_u24 v90, 205, v89
  v_lshrrev_b32 v90, 11, v90
  v_mul_u32_u24 v91, 10, v90
  v_sub_u32 v89, v89, v91
  v_mul_u32_u24 v90, 10240, v90
  v_lshl_add_u32 v90, v89, 4, v90
  v_mul_u32_u24 v88, 160, v88
  v_add_u32 v94, v88, v90
  s_add_u32 m0, s53, 32768
  s_nop 0
  buffer_load_dwordx4 v94, s[8:11], s82 offen sc1 lds
  s_waitcnt lgkmcnt(3)
  v_mfma_f32_16x16x32_bf16 v[16:19], v[44:47], v[40:43], v[16:19]
  v_mfma_f32_16x16x32_bf16 v[20:23], v[48:51], v[40:43], v[20:23]
  s_add_u32 s76, s82, 5120
  s_add_u32 m0, s53, 40960
  s_nop 0
  buffer_load_dwordx4 v94, s[8:11], s76 offen sc1 lds
  s_waitcnt lgkmcnt(0)
  v_mfma_f32_16x16x32_bf16 v[16:19], v[64:67], v[60:63], v[16:19]
  v_mfma_f32_16x16x32_bf16 v[20:23], v[68:71], v[60:63], v[20:23]
ve_155:
  s_cmp_ge_u32 s3, 4
  s_cbranch_scc1 vb_156
  s_waitcnt vmcnt(4)
  s_barrier
  v_add_u32 v104, 0, v12
  ds_read_b128 v[40:43], v8 offset:16384
  ds_read_b128 v[44:47], v104 offset:0
  ds_read_b128 v[48:51], v104 offset:1024
  ds_read_b128 v[52:55], v104 offset:2048
  ds_read_b128 v[60:63], v9 offset:16384
  ds_read_b128 v[64:67], v104 offset:5120
  ds_read_b128 v[68:71], v104 offset:6144
  ds_read_b128 v[72:75], v104 offset:7168
  s_mul_i32 s76, s7, 20480
  s_add_u32 s76, s76, s83
  s_add_u32 s76, s76, s53
  s_add_u32 s76, s76, 0
  s_add_u32 m0, s53, 122880
  s_nop 0
  buffer_load_dwordx4 v14, s[8:11], s76 offen sc1 lds
  s_waitcnt lgkmcnt(4)
  v_mfma_f32_16x16x32_bf16 v[16:19], v[44:47], v[40:43], v[16:19]
  v_mfma_f32_16x16x32_bf16 v[20:23], v[48:51], v[40:43], v[20:23]
  v_mfma_f32_16x16x32_bf16 v[24:27], v[52:55], v[40:43], v[24:27]
  ds_read_b128 v[40:43], v10 offset:16384
  ds_read_b128 v[44:47], v104 offset:10240
  ds_read_b128 v[48:51], v104 offset:11264
  ds_read_b128 v[52:55], v104 offset:12288
  s_mul_i32 s76, s7, 20480
  s_add_u32 s76, s76, s83
  s_add_u32 s76, s76, s53
  s_add_u32 s76, s76, 4096
  s_add_u32 m0, s53, 126976
  s_nop 0
  buffer_load_dwordx4 v14, s[8:11], s76 offen sc1 lds
  s_waitcnt lgkmcnt(4)
  v_mfma_f32_16x16x32_bf16 v[16:19], v[64:67], v[60:63], v[16:19]
  v_mfma_f32_16x16x32_bf16 v[20:23], v[68:71], v[60:63], v[20:23]
  v_mfma_f32_16x16x32_bf16 v[24:27], v[72:75], v[60:63], v[24:27]
  ds_read_b128 v[60:63], v11 offset:16384
  ds_read_b128 v[64:67], v104 offset:15360
  ds_read_b128 v[68:71], v104 offset:16384
  ds_read_b128 v[72:75], v104 offset:17408
  s_lshl_b32 s56, s3, 2
  v_add_u32 v88, s56, v3
  v_and_b32 v89, 15, v88
  v_xor_b32 v89, v89, v2
  s_lshl_b32 s57, s7, 4
  v_add_u32 v89, s57, v89
  v_mul_u32_u24 v90, 205, v89
  v_lshrrev_b32 v90, 11, v90
  v_mul_u32_u24 v91, 10, v90
  v_sub_u32 v89, v89, v91
  v_mul_u32_u24 v90, 10240, v90
  v_lshl_add_u32 v90, v89, 4, v90
  v_mul_u32_u24 v88, 160, v88
  v_add_u32 v94, v88, v90
  s_add_u32 m0, s53, 49152
  s_nop 0
  buffer_load_dwordx4 v94, s[8:11], s82 offen sc1 lds
  s_waitcnt lgkmcnt(4)
  v_mfma_f32_16x16x32_bf16 v[16:19], v[44:47], v[40:43], v[16:19]
  v_mfma_f32_16x16x32_bf16 v[20:23], v[48:51], v[40:43], v[20:23]
  v_mfma_f32_16x16x32_bf16 v[24:27], v[52:55], v[40:43], v[24:27]
  s_add_u32 s76, s82, 5120
  s_add_u32 m0, s53, 57344
  s_nop 0
  buffer_load_dwordx4 v94, s[8:11], s76 offen sc1 lds
  s_waitcnt lgkmcnt(0)
  v_mfma_f32_16x16x32_bf16 v[16:19], v[64:67], v[60:63], v[16:19]
  v_mfma_f32_16x16x32_bf16 v[20:23], v[68:71], v[60:63], v[20:23]
  v_mfma_f32_16x16x32_bf16 v[24:27], v[72:75], v[60:63], v[24:27]
  s_branch ve_157
vb_156:
  s_waitcnt vmcnt(5)
  s_barrier
  v_add_u32 v104, 0, v12
  ds_read_b128 v[40:43], v8 offset:16384
  ds_read_b128 v[44:47], v104 offset:3072
  ds_read_b128 v[48:51], v104 offset:4096
  ds_read_b128 v[60:63], v9 offset:16384
  ds_read_b128 v[64:67], v104 offset:8192
  ds_read_b128 v[68:71], v104 offset:9216
  s_mul_i32 s76, s7, 20480
  s_add_u32 s76, s76, s83
  s_add_u32 s76, s76, s53
  s_add_u32 s76, s76, 4096
  s_add_u32 m0, s53, 126976
  s_nop 0
  buffer_load_dwordx4 v14, s[8:11], s76 offen sc1 lds
  s_waitcnt lgkmcnt(3)
  v_mfma_f32_16x16x32_bf16 v[16:19], v[44:47], v[40:43], v[16:19]
  v_mfma_f32_16x16x32_bf16 v[20:23], v[48:51], v[40:43], v[20:23]
  ds_read_b128 v[40:43], v10 offset:16384
  ds_read_b128 v[44:47], v104 offset:13312
  ds_read_b128 v[48:51], v104 offset:14336
  s_mul_i32 s76, s7, 20480
  s_add_u32 s76, s76, s83
  s_add_u32 s76, s76, s53
  s_add_u32 s76, s76, 8192
  s_add_u32 m0, s53, 131072
  s_nop 0
  buffer_load_dwordx4 v14, s[8:11], s76 offen sc1 lds
  s_mul_i32 s76, s7, 20480
  s_add_u32 s76, s76, s83
  s_add_u32 s76, s76, s53
  s_add_u32 s76, s76, 12288
  s_add_u32 m0, s53, 135168
  s_nop 0
  buffer_load_dwordx4 v14, s[8:11], s76 offen sc1 lds
  s_waitcnt lgkmcnt(3)
  v_mfma_f32_16x16x32_bf16 v[16:19], v[64:67], v[60:63], v[16:19]
  v_mfma_f32_16x16x32_bf16 v[20:23], v[68:71], v[60:63], v[20:23]
  ds_read_b128 v[60:63], v11 offset:16384
  ds_read_b128 v[64:67], v104 offset:18432
  ds_read_b128 v[68:71], v104 offset:19456
  s_lshl_b32 s56, s3, 2
  v_add_u32 v88, s56, v3
  v_and_b32 v89, 15, v88
  v_xor_b32 v89, v89, v2
  s_lshl_b32 s57, s7, 4
  v_add_u32 v89, s57, v89
  v_mul_u32_u24 v90, 205, v89
  v_lshrrev_b32 v90, 11, v90
  v_mul_u32_u24 v91, 10, v90
  v_sub_u32 v89, v89, v91
  v_mul_u32_u24 v90, 10240, v90
  v_lshl_add_u32 v90, v89, 4, v90
  v_mul_u32_u24 v88, 160, v88
  v_add_u32 v94, v88, v90
  s_add_u32 m0, s53, 49152
  s_nop 0
  buffer_load_dwordx4 v94, s[8:11], s82 offen sc1 lds
  s_waitcnt lgkmcnt(3)
  v_mfma_f32_16x16x32_bf16 v[16:19], v[44:47], v[40:43], v[16:19]
  v_mfma_f32_16x16x32_bf16 v[20:23], v[48:51], v[40:43], v[20:23]
  s_add_u32 s76, s82, 5120
  s_add_u32 m0, s53, 57344
  s_nop 0
  buffer_load_dwordx4 v94, s[8:11], s76 offen sc1 lds
  s_waitcnt lgkmcnt(0)
  v_mfma_f32_16x16x32_bf16 v[16:19], v[64:67], v[60:63], v[16:19]
  v_mfma_f32_16x16x32_bf16 v[20:23], v[68:71], v[60:63], v[20:23]
ve_157:
  s_cmp_ge_u32 s3, 4
  s_cbranch_scc1 vb_158
  s_waitcnt vmcnt(4)
  s_barrier
  v_add_u32 v104, 20480, v12
  ds_read_b128 v[40:43], v8 offset:32768
  ds_read_b128 v[44:47], v104 offset:0
  ds_read_b128 v[48:51], v104 offset:1024
  ds_read_b128 v[52:55], v104 offset:2048
  ds_read_b128 v[60:63], v9 offset:32768
  ds_read_b128 v[64:67], v104 offset:5120
  ds_read_b128 v[68:71], v104 offset:6144
  ds_read_b128 v[72:75], v104 offset:7168
  s_mul_i32 s76, s54, 20480
  s_add_u32 s76, s76, s83
  s_add_u32 s76, s76, s53
  s_add_u32 s76, s76, 0
  s_add_u32 m0, s53, 81920
  s_nop 0
  buffer_load_dwordx4 v14, s[8:11], s76 offen sc1 lds
  s_waitcnt lgkmcnt(4)
  v_mfma_f32_16x16x32_bf16 v[16:19], v[44:47], v[40:43], v[16:19]
  v_mfma_f32_16x16x32_bf16 v[20:23], v[48:51], v[40:43], v[20:23]
  v_mfma_f32_16x16x32_bf16 v[24:27], v[52:55], v[40:43], v[24:27]
  ds_read_b128 v[40:43], v10 offset:32768
  ds_read_b128 v[44:47], v104 offset:10240
  ds_read_b128 v[48:51], v104 offset:11264
  ds_read_b128 v[52:55], v104 offset:12288
  s_mul_i32 s76, s54, 20480
  s_add_u32 s76, s76, s83
  s_add_u32 s76, s76, s53
  s_add_u32 s76, s76, 4096
  s_add_u32 m0, s53, 86016
  s_nop 0
  buffer_load_dwordx4 v14, s[8:11], s76 offen sc1 lds
  s_waitcnt lgkmcnt(4)
  v_mfma_f32_16x16x32_bf16 v[16:19], v[64:67], v[60:63], v[16:19]
  v_mfma_f32_16x16x32_bf16 v[20:23], v[68:71], v[60:63], v[20:23]
  v_mfma_f32_16x16x32_bf16 v[24:27], v[72:75], v[60:63], v[24:27]
  ds_read_b128 v[60:63], v11 offset:32768
  ds_read_b128 v[64:67], v104 offset:15360
  ds_read_b128 v[68:71], v104 offset:16384
  ds_read_b128 v[72:75], v104 offset:17408
  s_lshl_b32 s56, s3, 2
  v_add_u32 v88, s56, v3
  v_and_b32 v89, 15, v88
  v_xor_b32 v89, v89, v2
  s_lshl_b32 s57, s54, 4
  v_add_u32 v89, s57, v89
  v_mul_u32_u24 v90, 205, v89
  v_lshrrev_b32 v90, 11, v90
  v_mul_u32_u24 v91, 10, v90
  v_sub_u32 v89, v89, v91
  v_mul_u32_u24 v90, 10240, v90
  v_lshl_add_u32 v90, v89, 4, v90
  v_mul_u32_u24 v88, 160, v88
  v_add_u32 v94, v88, v90
  s_add_u32 m0, s53, 65536
  s_nop 0
  buffer_load_dwordx4 v94, s[8:11], s82 offen sc1 lds
  s_waitcnt lgkmcnt(4)
  v_mfma_f32_16x16x32_bf16 v[16:19], v[44:47], v[40:43], v[16:19]
  v_mfma_f32_16x16x32_bf16 v[20:23], v[48:51], v[40:43], v[20:23]
  v_mfma_f32_16x16x32_bf16 v[24:27], v[52:55], v[40:43], v[24:27]
  s_add_u32 s76, s82, 5120
  s_add_u32 m0, s53, 73728
  s_nop 0
  buffer_load_dwordx4 v94, s[8:11], s76 offen sc1 lds
  s_waitcnt lgkmcnt(0)
  v_mfma_f32_16x16x32_bf16 v[16:19], v[64:67], v[60:63], v[16:19]
  v_mfma_f32_16x16x32_bf16 v[20:23], v[68:71], v[60:63], v[20:23]
  v_mfma_f32_16x16x32_bf16 v[24:27], v[72:75], v[60:63], v[24:27]
  s_branch ve_159
vb_158:
  s_waitcnt vmcnt(5)
  s_barrier
  v_add_u32 v104, 20480, v12
  ds_read_b128 v[40:43], v8 offset:32768
  ds_read_b128 v[44:47], v104 offset:3072
  ds_read_b128 v[48:51], v104 offset:4096
  ds_read_b128 v[60:63], v9 offset:32768
  ds_read_b128 v[64:67], v104 offset:8192
  ds_read_b128 v[68:71], v104 offset:9216
  s_mul_i32 s76, s54, 20480
  s_add_u32 s76, s76, s83
  s_add_u32 s76, s76, s53
  s_add_u32 s76, s76, 4096
  s_add_u32 m0, s53, 86016
  s_nop 0
  buffer_load_dwordx4 v14, s[8:11], s76 offen sc1 lds
  s_waitcnt lgkmcnt(3)
  v_mfma_f32_16x16x32_bf16 v[16:19], v[44:47], v[40:43], v[16:19]
  v_mfma_f32_16x16x32_bf16 v[20:23], v[48:51], v[40:43], v[20:23]
  ds_read_b128 v[40:43], v10 offset:32768
  ds_read_b128 v[44:47], v104 offset:13312
  ds_read_b128 v[48:51], v104 offset:14336
  s_mul_i32 s76, s54, 20480
  s_add_u32 s76, s76, s83
  s_add_u32 s76, s76, s53
  s_add_u32 s76, s76, 8192
  s_add_u32 m0, s53, 90112
  s_nop 0
  buffer_load_dwordx4 v14, s[8:11], s76 offen sc1 lds
  s_mul_i32 s76, s54, 20480
  s_add_u32 s76, s76, s83
  s_add_u32 s76, s76, s53
  s_add_u32 s76, s76, 12288
  s_add_u32 m0, s53, 94208
  s_nop 0
  buffer_load_dwordx4 v14, s[8:11], s76 offen sc1 lds
  s_waitcnt lgkmcnt(3)
  v_mfma_f32_16x16x32_bf16 v[16:19], v[64:67], v[60:63], v[16:19]
  v_mfma_f32_16x16x32_bf16 v[20:23], v[68:71], v[60:63], v[20:23]
  ds_read_b128 v[60:63], v11 offset:32768
  ds_read_b128 v[64:67], v104 offset:18432
  ds_read_b128 v[68:71], v104 offset:19456
  s_lshl_b32 s56, s3, 2
  v_add_u32 v88, s56, v3
  v_and_b32 v89, 15, v88
  v_xor_b32 v89, v89, v2
  s_lshl_b32 s57, s54, 4
  v_add_u32 v89, s57, v89
  v_mul_u32_u24 v90, 205, v89
  v_lshrrev_b32 v90, 11, v90
  v_mul_u32_u24 v91, 10, v90
  v_sub_u32 v89, v89, v91
  v_mul_u32_u24 v90, 10240, v90
  v_lshl_add_u32 v90, v89, 4, v90
  v_mul_u32_u24 v88, 160, v88
  v_add_u32 v94, v88, v90
  s_add_u32 m0, s53, 65536
  s_nop 0
  buffer_load_dwordx4 v94, s[8:11], s82 offen sc1 lds
  s_waitcnt lgkmcnt(3)
  v_mfma_f32_16x16x32_bf16 v[16:19], v[44:47], v[40:43], v[16:19]
  v_mfma_f32_16x16x32_bf16 v[20:23], v[48:51], v[40:43], v[20:23]
  s_add_u32 s76, s82, 5120
  s_add_u32 m0, s53, 73728
  s_nop 0
  buffer_load_dwordx4 v94, s[8:11], s76 offen sc1 lds
  s_waitcnt lgkmcnt(0)
  v_mfma_f32_16x16x32_bf16 v[16:19], v[64:67], v[60:63], v[16:19]
  v_mfma_f32_16x16x32_bf16 v[20:23], v[68:71], v[60:63], v[20:23]
ve_159:
  s_cmp_ge_u32 s3, 4
  s_cbranch_scc1 vb_160
  s_waitcnt vmcnt(4)
  s_barrier
  v_add_u32 v104, 40960, v12
  ds_read_b128 v[40:43], v8 offset:49152
  ds_read_b128 v[44:47], v104 offset:0
  ds_read_b128 v[48:51], v104 offset:1024
  ds_read_b128 v[52:55], v104 offset:2048
  ds_read_b128 v[60:63], v9 offset:49152
  ds_read_b128 v[64:67], v104 offset:5120
  ds_read_b128 v[68:71], v104 offset:6144
  ds_read_b128 v[72:75], v104 offset:7168
  s_waitcnt lgkmcnt(4)
  v_mfma_f32_16x16x32_bf16 v[16:19], v[44:47], v[40:43], v[16:19]
  v_mfma_f32_16x16x32_bf16 v[20:23], v[48:51], v[40:43], v[20:23]
  v_mfma_f32_16x16x32_bf16 v[24:27], v[52:55], v[40:43], v[24:27]
  ds_read_b128 v[40:43], v10 offset:49152
  ds_read_b128 v[44:47], v104 offset:10240
  ds_read_b128 v[48:51], v104 offset:11264
  ds_read_b128 v[52:55], v104 offset:12288
  s_waitcnt lgkmcnt(4)
  v_mfma_f32_16x16x32_bf16 v[16:19], v[64:67], v[60:63], v[16:19]
  v_mfma_f32_16x16x32_bf16 v[20:23], v[68:71], v[60:63], v[20:23]
  v_mfma_f32_16x16x32_bf16 v[24:27], v[72:75], v[60:63], v[24:27]
  ds_read_b128 v[60:63], v11 offset:49152
  ds_read_b128 v[64:67], v104 offset:15360
  ds_read_b128 v[68:71], v104 offset:16384
  ds_read_b128 v[72:75], v104 offset:17408
  s_waitcnt lgkmcnt(4)
  v_mfma_f32_16x16x32_bf16 v[16:19], v[44:47], v[40:43], v[16:19]
  v_mfma_f32_16x16x32_bf16 v[20:23], v[48:51], v[40:43], v[20:23]
  v_mfma_f32_16x16x32_bf16 v[24:27], v[52:55], v[40:43], v[24:27]
  s_waitcnt lgkmcnt(0)
  v_mfma_f32_16x16x32_bf16 v[16:19], v[64:67], v[60:63], v[16:19]
  v_mfma_f32_16x16x32_bf16 v[20:23], v[68:71], v[60:63], v[20:23]
  v_mfma_f32_16x16x32_bf16 v[24:27], v[72:75], v[60:63], v[24:27]
  s_branch ve_161
vb_160:
  s_waitcnt vmcnt(5)
  s_barrier
  v_add_u32 v104, 40960, v12
  ds_read_b128 v[40:43], v8 offset:49152
  ds_read_b128 v[44:47], v104 offset:3072
  ds_read_b128 v[48:51], v104 offset:4096
  ds_read_b128 v[60:63], v9 offset:49152
  ds_read_b128 v[64:67], v104 offset:8192
  ds_read_b128 v[68:71], v104 offset:9216
  s_waitcnt lgkmcnt(3)
  v_mfma_f32_16x16x32_bf16 v[16:19], v[44:47], v[40:43], v[16:19]
  v_mfma_f32_16x16x32_bf16 v[20:23], v[48:51], v[40:43], v[20:23]
  ds_read_b128 v[40:43], v10 offset:49152
  ds_read_b128 v[44:47], v104 offset:13312
  ds_read_b128 v[48:51], v104 offset:14336
  s_waitcnt lgkmcnt(3)
  v_mfma_f32_16x16x32_bf16 v[16:19], v[64:67], v[60:63], v[16:19]
  v_mfma_f32_16x16x32_bf16 v[20:23], v[68:71], v[60:63], v[20:23]
  ds_read_b128 v[60:63], v11 offset:49152
  ds_read_b128 v[64:67], v104 offset:18432
  ds_read_b128 v[68:71], v104 offset:19456
  s_waitcnt lgkmcnt(3)
  v_mfma_f32_16x16x32_bf16 v[16:19], v[44:47], v[40:43], v[16:19]
  v_mfma_f32_16x16x32_bf16 v[20:23], v[48:51], v[40:43], v[20:23]
  s_waitcnt lgkmcnt(0)
  v_mfma_f32_16x16x32_bf16 v[16:19], v[64:67], v[60:63], v[16:19]
  v_mfma_f32_16x16x32_bf16 v[20:23], v[68:71], v[60:63], v[20:23]
ve_161:
  s_cmp_ge_u32 s3, 4
  s_cbranch_scc1 vb_162
  s_waitcnt vmcnt(0)
  s_barrier
  v_add_u32 v104, 0, v12
  v_add_u32 v80, 65536, v8
  v_add_u32 v81, 65536, v9
  v_add_u32 v82, 65536, v10
  v_add_u32 v83, 65536, v11
  ds_read_b128 v[40:43], v80 offset:0
  ds_read_b128 v[44:47], v104 offset:0
  ds_read_b128 v[48:51], v104 offset:1024
  ds_read_b128 v[52:55], v104 offset:2048
  ds_read_b128 v[60:63], v81 offset:0
  ds_read_b128 v[64:67], v104 offset:5120
  ds_read_b128 v[68:71], v104 offset:6144
  ds_read_b128 v[72:75], v104 offset:7168
  s_waitcnt lgkmcnt(4)
  v_mfma_f32_16x16x32_bf16 v[16:19], v[44:47], v[40:43], v[16:19]
  v_mfma_f32_16x16x32_bf16 v[20:23], v[48:51], v[40:43], v[20:23]
  v_mfma_f32_16x16x32_bf16 v[24:27], v[52:55], v[40:43], v[24:27]
  ds_read_b128 v[40:43], v82 offset:0
  ds_read_b128 v[44:47], v104 offset:10240
  ds_read_b128 v[48:51], v104 offset:11264
  ds_read_b128 v[52:55], v104 offset:12288
  s_waitcnt lgkmcnt(4)
  v_mfma_f32_16x16x32_bf16 v[16:19], v[64:67], v[60:63], v[16:19]
  v_mfma_f32_16x16x32_bf16 v[20:23], v[68:71], v[60:63], v[20:23]
  v_mfma_f32_16x16x32_bf16 v[24:27], v[72:75], v[60:63], v[24:27]
  ds_read_b128 v[60:63], v83 offset:0
  ds_read_b128 v[64:67], v104 offset:15360
  ds_read_b128 v[68:71], v104 offset:16384
  ds_read_b128 v[72:75], v104 offset:17408
  s_waitcnt lgkmcnt(4)
  v_mfma_f32_16x16x32_bf16 v[16:19], v[44:47], v[40:43], v[16:19]
  v_mfma_f32_16x16x32_bf16 v[20:23], v[48:51], v[40:43], v[20:23]
  v_mfma_f32_16x16x32_bf16 v[24:27], v[52:55], v[40:43], v[24:27]
  s_waitcnt lgkmcnt(0)
  v_mfma_f32_16x16x32_bf16 v[16:19], v[64:67], v[60:63], v[16:19]
  v_mfma_f32_16x16x32_bf16 v[20:23], v[68:71], v[60:63], v[20:23]
  v_mfma_f32_16x16x32_bf16 v[24:27], v[72:75], v[60:63], v[24:27]
  s_branch ve_163
vb_162:
  s_waitcnt vmcnt(0)
  s_barrier
  v_add_u32 v104, 0, v12
  v_add_u32 v80, 65536, v8
  v_add_u32 v81, 65536, v9
  v_add_u32 v82, 65536, v10
  v_add_u32 v83, 65536, v11
  ds_read_b128 v[40:43], v80 offset:0
  ds_read_b128 v[44:47], v104 offset:3072
  ds_read_b128 v[48:51], v104 offset:4096
  ds_read_b128 v[60:63], v81 offset:0
  ds_read_b128 v[64:67], v104 offset:8192
  ds_read_b128 v[68:71], v104 offset:9216
  s_waitcnt lgkmcnt(3)
  v_mfma_f32_16x16x32_bf16 v[16:19], v[44:47], v[40:43], v[16:19]
  v_mfma_f32_16x16x32_bf16 v[20:23], v[48:51], v[40:43], v[20:23]
  ds_read_b128 v[40:43], v82 offset:0
  ds_read_b128 v[44:47], v104 offset:13312
  ds_read_b128 v[48:51], v104 offset:14336
  s_waitcnt lgkmcnt(3)
  v_mfma_f32_16x16x32_bf16 v[16:19], v[64:67], v[60:63], v[16:19]
  v_mfma_f32_16x16x32_bf16 v[20:23], v[68:71], v[60:63], v[20:23]
  ds_read_b128 v[60:63], v83 offset:0
  ds_read_b128 v[64:67], v104 offset:18432
  ds_read_b128 v[68:71], v104 offset:19456
  s_waitcnt lgkmcnt(3)
  v_mfma_f32_16x16x32_bf16 v[16:19], v[44:47], v[40:43], v[16:19]
  v_mfma_f32_16x16x32_bf16 v[20:23], v[48:51], v[40:43], v[20:23]
  s_waitcnt lgkmcnt(0)
  v_mfma_f32_16x16x32_bf16 v[16:19], v[64:67], v[60:63], v[16:19]
  v_mfma_f32_16x16x32_bf16 v[20:23], v[68:71], v[60:63], v[20:23]
ve_163:
  s_nop 7
  v_mul_f32 v80, 0xbfb8aa3b, v6
  v_exp_f32 v80, v80
  s_nop 0
  v_add_f32 v80, 1.0, v80
  v_rcp_f32 v80, v80
  v_mul_u32_u24 v81, 1280, v2
  v_lshl_add_u32 v81, v3, 3, v81
  s_lshl_b32 s56, s48, 6
  s_lshl_b32 s57, s51, 4
  s_add_u32 s56, s56, s57
  s_mul_i32 s56, s56, 1280
  s_mul_i32 s57, s49, 160
  s_add_u32 s56, s56, s57
  s_cmp_ge_u32 s3, 4
  s_cbranch_scc1 fin_164
  v_sub_f32 v16, v16, v28
  v_sub_f32 v17, v17, v29
  v_sub_f32 v18, v18, v30
  v_sub_f32 v19, v19, v31
  v_fma_f32 v16, v16, v80, v28
  v_fma_f32 v17, v17, v80, v29
  v_fma_f32 v18, v18, v80, v30
  v_fma_f32 v19, v19, v80, v31
  v_cvt_pk_bf16_f32 v16, v16, v17
  v_cvt_pk_bf16_f32 v17, v18, v19
  buffer_store_dwordx2 v[16:17], v81, s[32:35], s56 offen offset:0
  v_sub_f32 v20, v20, v32
  v_sub_f32 v21, v21, v33
  v_sub_f32 v22, v22, v34
  v_sub_f32 v23, v23, v35
  v_fma_f32 v20, v20, v80, v32
  v_fma_f32 v21, v21, v80, v33
  v_fma_f32 v22, v22, v80, v34
  v_fma_f32 v23, v23, v80, v35
  v_cvt_pk_bf16_f32 v20, v20, v21
  v_cvt_pk_bf16_f32 v21, v22, v23
  buffer_store_dwordx2 v[20:21], v81, s[32:35], s56 offen offset:32
  v_sub_f32 v24, v24, v36
  v_sub_f32 v25, v25, v37
  v_sub_f32 v26, v26, v38
  v_sub_f32 v27, v27, v39
  v_fma_f32 v24, v24, v80, v36
  v_fma_f32 v25, v25, v80, v37
  v_fma_f32 v26, v26, v80, v38
  v_fma_f32 v27, v27, v80, v39
  v_cvt_pk_bf16_f32 v24, v24, v25
  v_cvt_pk_bf16_f32 v25, v26, v27
  buffer_store_dwordx2 v[24:25], v81, s[32:35], s56 offen offset:64
  s_branch fin_165
fin_164:
  v_sub_f32 v16, v16, v28
  v_sub_f32 v17, v17, v29
  v_sub_f32 v18, v18, v30
  v_sub_f32 v19, v19, v31
  v_fma_f32 v16, v16, v80, v28
  v_fma_f32 v17, v17, v80, v29
  v_fma_f32 v18, v18, v80, v30
  v_fma_f32 v19, v19, v80, v31
  v_cvt_pk_bf16_f32 v16, v16, v17
  v_cvt_pk_bf16_f32 v17, v18, v19
  buffer_store_dwordx2 v[16:17], v81, s[32:35], s56 offen offset:96
  v_sub_f32 v20, v20, v32
  v_sub_f32 v21, v21, v33
  v_sub_f32 v22, v22, v34
  v_sub_f32 v23, v23, v35
  v_fma_f32 v20, v20, v80, v32
  v_fma_f32 v21, v21, v80, v33
  v_fma_f32 v22, v22, v80, v34
  v_fma_f32 v23, v23, v80, v35
  v_cvt_pk_bf16_f32 v20, v20, v21
  v_cvt_pk_bf16_f32 v21, v22, v23
  buffer_store_dwordx2 v[20:21], v81, s[32:35], s56 offen offset:128
fin_165:
  s_cmp_lg_u32 s2, 0
  s_cbranch_scc1 ep_166
  s_cmp_lg_u32 s3, 0
  s_cbranch_scc1 ep_166
  v_mov_b32 v15, s50
  s_mov_b32 s56, 17956864
  s_mov_b64 exec, 1
  buffer_store_dword v15, off, s[8:11], s56 sc1
  s_mov_b64 exec, -1
ep_166:
L_fin:
  s_waitcnt vmcnt(0)
L_end:
  s_endpgm
L_slow:
  s_waitcnt lgkmcnt(0)
  s_mov_b32 s83, 1
  v_lshlrev_b32 v16, 2, v0
  v_add_u32 v16, 153600, v16
  v_mov_b32 v17, 0xff800000
  v_cmp_gt_u32 vcc, 256, v0
  s_and_saveexec_b64 s[56:57], vcc
  ds_write_b32 v16, v17
  s_mov_b64 exec, s[56:57]
  s_waitcnt lgkmcnt(0)
  s_barrier
  v_lshlrev_b32 v60, 4, v1
  v_lshlrev_b32 v61, 3, v1
  v_min_u32 v62, 20, v4
  v_mad_u32_u24 v62, v5, 21, v62
  v_lshlrev_b32 v62, 4, v62
  s_lshl_b32 s56, s3, 2
  s_xor_b32 s57, s56, 16
  s_add_u32 s56, s56, 162832
  s_add_u32 s57, s57, 162832
  v_mov_b32 v8, s56
  v_mov_b32 v9, s57
  v_mov_b32 v63, 0
  v_mov_b32 v48, 0xff800000
  v_mov_b32 v49, 0xff800000
  v_mov_b32 v50, 0xff800000
  v_mov_b32 v51, 0xff800000
  s_mov_b32 s72, s74
mx_167:
  buffer_load_dwordx4 v[64:67], v60, s[8:11], s72 offen sc1
  buffer_load_dwordx2 v[68:69], v61, s[8:11], s72 offen offset:1024 sc1
  s_waitcnt vmcnt(0)
  v_mfma_f32_32x32x16_bf16 v[16:31], v[64:67], a[64:67], 0
  v_mfma_f32_32x32x8_bf16 v[16:31], v[68:69], a[80:81], v[16:31]
  s_nop 15
  v_max3_f32 v48, v16, v17, v48
  v_max3_f32 v48, v18, v19, v48
  v_max3_f32 v48, v20, v21, v48
  v_max3_f32 v48, v22, v23, v48
  v_max3_f32 v48, v24, v25, v48
  v_max3_f32 v48, v26, v27, v48
  v_max3_f32 v48, v28, v29, v48
  v_max3_f32 v48, v30, v31, v48
  v_mfma_f32_32x32x16_bf16 v[16:31], v[64:67], a[68:71], 0
  v_mfma_f32_32x32x8_bf16 v[16:31], v[68:69], a[82:83], v[16:31]
  s_nop 15
  v_max3_f32 v49, v16, v17, v49
  v_max3_f32 v49, v18, v19, v49
  v_max3_f32 v49, v20, v21, v49
  v_max3_f32 v49, v22, v23, v49
  v_max3_f32 v49, v24, v25, v49
  v_max3_f32 v49, v26, v27, v49
  v_max3_f32 v49, v28, v29, v49
  v_max3_f32 v49, v30, v31, v49
  v_mfma_f32_32x32x16_bf16 v[16:31], v[64:67], a[72:75], 0
  v_mfma_f32_32x32x8_bf16 v[16:31], v[68:69], a[84:85], v[16:31]
  s_nop 15
  v_max3_f32 v50, v16, v17, v50
  v_max3_f32 v50, v18, v19, v50
  v_max3_f32 v50, v20, v21, v50
  v_max3_f32 v50, v22, v23, v50
  v_max3_f32 v50, v24, v25, v50
  v_max3_f32 v50, v26, v27, v50
  v_max3_f32 v50, v28, v29, v50
  v_max3_f32 v50, v30, v31, v50
  v_mfma_f32_32x32x16_bf16 v[16:31], v[64:67], a[76:79], 0
  v_mfma_f32_32x32x8_bf16 v[16:31], v[68:69], a[86:87], v[16:31]
  s_nop 15
  v_max3_f32 v51, v16, v17, v51
  v_max3_f32 v51, v18, v19, v51
  v_max3_f32 v51, v20, v21, v51
  v_max3_f32 v51, v22, v23, v51
  v_max3_f32 v51, v24, v25, v51
  v_max3_f32 v51, v26, v27, v51
  v_max3_f32 v51, v28, v29, v51
  v_max3_f32 v51, v30, v31, v51
  s_add_u32 s72, s72, 2880
  s_cmp_lt_u32 s72, s73
  s_cbranch_scc1 mx_167
  s_lshl_b32 s56, s70, 9
  s_add_u32 s56, s56, 153600
  v_lshlrev_b32 v16, 2, v4
  v_add_u32 v16, s56, v16
  ds_max_f32 v16, v48 offset:0
  ds_max_f32 v16, v49 offset:128
  ds_max_f32 v16, v50 offset:256
  ds_max_f32 v16, v51 offset:384
  s_waitcnt lgkmcnt(0)
  s_barrier
  ds_read_b32 v48, v16 offset:0
  ds_read_b32 v49, v16 offset:128
  ds_read_b32 v50, v16 offset:256
  ds_read_b32 v51, v16 offset:384
  s_waitcnt lgkmcnt(0)
  v_cmp_le_u32 vcc, 32, v1
  s_and_saveexec_b64 s[56:57], vcc
  v_sub_f32 v48, 0, v48
  v_cvt_pk_bf16_f32 v20, v48, v48
  v_and_b32 v22, 0xffff0000, v20
  v_sub_f32 v48, v48, v22
  v_cvt_pk_bf16_f32 v21, v48, v48
  v_and_b32 v22, 0xffff0000, v21
  v_sub_f32 v48, v48, v22
  v_cvt_pk_bf16_f32 v22, v48, v48
  v_and_b32 v20, 0xffff, v20
  v_and_b32 v21, 0xffff0000, v21
  v_or_b32 v20, v20, v21
  v_and_b32 v22, 0xffff, v22
  v_accvgpr_write_b32 a80, v20
  v_accvgpr_write_b32 a81, v22
  v_sub_f32 v49, 0, v49
  v_cvt_pk_bf16_f32 v20, v49, v49
  v_and_b32 v22, 0xffff0000, v20
  v_sub_f32 v49, v49, v22
  v_cvt_pk_bf16_f32 v21, v49, v49
  v_and_b32 v22, 0xffff0000, v21
  v_sub_f32 v49, v49, v22
  v_cvt_pk_bf16_f32 v22, v49, v49
  v_and_b32 v20, 0xffff, v20
  v_and_b32 v21, 0xffff0000, v21
  v_or_b32 v20, v20, v21
  v_and_b32 v22, 0xffff, v22
  v_accvgpr_write_b32 a82, v20
  v_accvgpr_write_b32 a83, v22
  v_sub_f32 v50, 0, v50
  v_cvt_pk_bf16_f32 v20, v50, v50
  v_and_b32 v22, 0xffff0000, v20
  v_sub_f32 v50, v50, v22
  v_cvt_pk_bf16_f32 v21, v50, v50
  v_and_b32 v22, 0xffff0000, v21
  v_sub_f32 v50, v50, v22
  v_cvt_pk_bf16_f32 v22, v50, v50
  v_and_b32 v20, 0xffff, v20
  v_and_b32 v21, 0xffff0000, v21
  v_or_b32 v20, v20, v21
  v_and_b32 v22, 0xffff, v22
  v_accvgpr_write_b32 a84, v20
  v_accvgpr_write_b32 a85, v22
  v_sub_f32 v51, 0, v51
  v_cvt_pk_bf16_f32 v20, v51, v51
  v_and_b32 v22, 0xffff0000, v20
  v_sub_f32 v51, v51, v22
  v_cvt_pk_bf16_f32 v21, v51, v51
  v_and_b32 v22, 0xffff0000, v21
  v_sub_f32 v51, v51, v22
  v_cvt_pk_bf16_f32 v22, v51, v51
  v_and_b32 v20, 0xffff, v20
  v_and_b32 v21, 0xffff0000, v21
  v_or_b32 v20, v20, v21
  v_and_b32 v22, 0xffff, v22
  v_accvgpr_write_b32 a86, v20
  v_accvgpr_write_b32 a87, v22
  s_mov_b64 exec, s[56:57]
  v_accvgpr_write_b32 a0, 0
  v_accvgpr_write_b32 a1, 0
  v_accvgpr_write_b32 a2, 0
  v_accvgpr_write_b32 a3, 0
  v_accvgpr_write_b32 a4, 0
  v_accvgpr_write_b32 a5, 0
  v_accvgpr_write_b32 a6, 0
  v_accvgpr_write_b32 a7, 0
  v_accvgpr_write_b32 a8, 0
  v_accvgpr_write_b32 a9, 0
  v_accvgpr_write_b32 a10, 0
  v_accvgpr_write_b32 a11, 0
  v_accvgpr_write_b32 a12, 0
  v_accvgpr_write_b32 a13, 0
  v_accvgpr_write_b32 a14, 0
  v_accvgpr_write_b32 a15, 0
  v_accvgpr_write_b32 a16, 0
  v_accvgpr_write_b32 a17, 0
  v_accvgpr_write_b32 a18, 0
  v_accvgpr_write_b32 a19, 0
  v_accvgpr_write_b32 a20, 0
  v_accvgpr_write_b32 a21, 0
  v_accvgpr_write_b32 a22, 0
  v_accvgpr_write_b32 a23, 0
  v_accvgpr_write_b32 a24, 0
  v_accvgpr_write_b32 a25, 0
  v_accvgpr_write_b32 a26, 0
  v_accvgpr_write_b32 a27, 0
  v_accvgpr_write_b32 a28, 0
  v_accvgpr_write_b32 a29, 0
  v_accvgpr_write_b32 a30, 0
  v_accvgpr_write_b32 a31, 0
  v_accvgpr_write_b32 a32, 0
  v_accvgpr_write_b32 a33, 0
  v_accvgpr_write_b32 a34, 0
  v_accvgpr_write_b32 a35, 0
  v_accvgpr_write_b32 a36, 0
  v_accvgpr_write_b32 a37, 0
  v_accvgpr_write_b32 a38, 0
  v_accvgpr_write_b32 a39, 0
  v_accvgpr_write_b32 a40, 0
  v_accvgpr_write_b32 a41, 0
  v_accvgpr_write_b32 a42, 0
  v_accvgpr_write_b32 a43, 0
  v_accvgpr_write_b32 a44, 0
  v_accvgpr_write_b32 a45, 0
  v_accvgpr_write_b32 a46, 0
  v_accvgpr_write_b32 a47, 0
  v_accvgpr_write_b32 a48, 0
  v_accvgpr_write_b32 a49, 0
  v_accvgpr_write_b32 a50, 0
  v_accvgpr_write_b32 a51, 0
  v_accvgpr_write_b32 a52, 0
  v_accvgpr_write_b32 a53, 0
  v_accvgpr_write_b32 a54, 0
  v_accvgpr_write_b32 a55, 0
  v_accvgpr_write_b32 a56, 0
  v_accvgpr_write_b32 a57, 0
  v_accvgpr_write_b32 a58, 0
  v_accvgpr_write_b32 a59, 0
  v_accvgpr_write_b32 a60, 0
  v_accvgpr_write_b32 a61, 0
  v_accvgpr_write_b32 a62, 0
  v_accvgpr_write_b32 a63, 0
  s_add_u32 s58, s65, 0
  s_cmp_ge_u32 s58, s64
  s_cselect_b32 s59, s64, 0
  s_sub_u32 s58, s58, s59
  s_mul_i32 s72, s58, 2880
  s_add_u32 s72, s72, s74
  buffer_load_dwordx4 v[64:67], v60, s[8:11], s72 offen sc1
  buffer_load_dwordx2 v[76:77], v61, s[8:11], s72 offen offset:1024 sc1
  buffer_load_dwordx4 v[68:71], v62, s[8:11], s72 offen offset:1536 sc1
  buffer_load_dwordx4 v[72:75], v62, s[8:11], s72 offen offset:2208 sc1
  s_add_u32 s72, s72, 2880
  s_cmp_ge_u32 s72, s73
  s_cselect_b32 s72, s74, s72
  buffer_load_dwordx4 v[80:83], v60, s[8:11], s72 offen sc1
  buffer_load_dwordx2 v[92:93], v61, s[8:11], s72 offen offset:1024 sc1
  buffer_load_dwordx4 v[84:87], v62, s[8:11], s72 offen offset:1536 sc1
  buffer_load_dwordx4 v[88:91], v62, s[8:11], s72 offen offset:2208 sc1
  s_add_u32 s72, s72, 2880
  s_cmp_ge_u32 s72, s73
  s_cselect_b32 s72, s74, s72
  buffer_load_dwordx4 v[96:99], v60, s[8:11], s72 offen sc1
  buffer_load_dwordx2 v[108:109], v61, s[8:11], s72 offen offset:1024 sc1
  buffer_load_dwordx4 v[100:103], v62, s[8:11], s72 offen offset:1536 sc1
  buffer_load_dwordx4 v[104:107], v62, s[8:11], s72 offen offset:2208 sc1
  s_add_u32 s72, s72, 2880
  s_cmp_ge_u32 s72, s73
  s_cselect_b32 s72, s74, s72
  s_lshr_b32 s75, s64, 1
  s_mov_b32 s67, 1
  s_branch attn_103
.section .rodata,"a"
.p2align 6
.amdhsa_kernel gated_mix__grouped_kv_mqa__spectral_gfnet__prompt_kernel
  .amdhsa_next_free_vgpr 256
  .amdhsa_next_free_sgpr 102
  .amdhsa_accum_offset 128
  .amdhsa_group_segment_fixed_size 0
  .amdhsa_kernarg_size 96
  .amdhsa_user_sgpr_count 2
  .amdhsa_user_sgpr_kernarg_segment_ptr 1
  .amdhsa_system_sgpr_workgroup_id_x 1
  .amdhsa_float_denorm_mode_32 3
  .amdhsa_float_denorm_mode_16_64 3
.end_amdhsa_kernel
```
